```python
import torch

def _softmax(x, axis=-1):
    return torch.softmax(x, dim=axis)
def _gelu(x):
    return torch.nn.functional.gelu(x, approximate="tanh")
def _silu(x):
    return torch.nn.functional.silu(x)
def _sigmoid(x):
    return torch.sigmoid(x)
def _layernorm(x, axis=-1, eps=1e-5):
    m = x.mean(dim=axis, keepdim=True)
    v = x.var(dim=axis, keepdim=True, unbiased=False)
    return (x - m) / torch.sqrt(v + eps)
def _scatter_add(tgt, idx, src, axis=0):
    return tgt.clone().index_add_(axis, idx, src)
def _segment_sum(src, seg, n):
    out = torch.zeros((n,) + src.shape[1:], dtype=src.dtype)
    return out.index_add_(0, seg, src)
def _pad(x, pw):
    flat = tuple(v for pair in reversed(pw) for v in pair)
    return torch.nn.functional.pad(x, flat)

kernel_name = 'concat_heads__ssm_conv_h3__grouped_kv_mqa__prompt'

def setup_inputs():

    _w = (lambda a: (lambda t: t.to(torch.bfloat16) if t.is_floating_point() else t)(torch.as_tensor(a)))
    def _A_setup():
        B, S, D = 1, 2048, 576
        ks = 4
        return {
            "q": _w((lambda *s: torch.randn(*s, dtype=torch.bfloat16) * 0.05)(B, S, D)),
            "k": _w((lambda *s: torch.randn(*s, dtype=torch.bfloat16) * 0.2)(B, S, D)),
            "v": _w((lambda *s: torch.randn(*s, dtype=torch.bfloat16) * 0.2)(B, S, D)),
            "shift_k": _w((lambda *s: torch.randn(*s, dtype=torch.bfloat16) * 0.2)(D, ks) * 0.5),
            "ssm_k": _w((lambda *s: torch.randn(*s, dtype=torch.bfloat16) * 0.8)(D, S) * (1.0 / S ** 0.5)),
            "ssm_D": _w((lambda *s: torch.randn(*s, dtype=torch.bfloat16) * 0.2)(D)),
        }
    _A_in = _A_setup()

    def _B_setup():
        B, S, D, H = 1, 2048, 576, 32
        Dh = D // H
        return {
            "x": _w((lambda *s: torch.randn(*s, dtype=torch.bfloat16) * 0.05)(B, S, D)),
            "wq": _w((lambda *s: torch.randn(*s, dtype=torch.bfloat16) * 0.8)(D, H * Dh)),
            "wk": _w((lambda *s: torch.randn(*s, dtype=torch.bfloat16) * 0.8)(D, Dh)),
            "wv": _w((lambda *s: torch.randn(*s, dtype=torch.bfloat16) * 0.05)(D, Dh)),
            "wo": _w((lambda *s: torch.randn(*s, dtype=torch.bfloat16) * 0.05)(H * Dh, D)),
        }
    _B_in = _B_setup()

    return {
        "A_q": _A_in["q"],
        "A_k": _A_in["k"],
        "A_v": _A_in["v"],
        "A_shift_k": _A_in["shift_k"],
        "A_ssm_k": _A_in["ssm_k"],
        "A_ssm_D": _A_in["ssm_D"],
        "B_x": _B_in["x"],
        "B_wq": _B_in["wq"],
        "B_wk": _B_in["wk"],
        "B_wv": _B_in["wv"],
        "B_wo": _B_in["wo"],
    }

def reference(A_q, A_k, A_v, A_shift_k, A_ssm_k, A_ssm_D, B_x, B_wq, B_wk, B_wv, B_wo):
    def _A_ref(q, k, v, shift_k, ssm_k, ssm_D):
        B, S, D = q.shape
        ks = shift_k.shape[-1]
        k_pad = _pad(k, ((0, 0), (ks - 1, 0), (0, 0)))
        k_shift = torch.zeros_like(k)
        for t in range(ks):
            k_shift = k_shift + k_pad[:, t:t + S, :] * shift_k[:, ks - 1 - t][None, None, :]
        kv = k_shift * v
        L = 2 * S
        kv_pad = _pad(kv, ((0, 0), (0, S), (0, 0)))
        kf_pad = _pad(ssm_k, ((0, 0), (0, S)))
        kv_f = (lambda x, axes=(-2,-1): torch.fft.rfft2(x.float(), dim=axes))(kv_pad[:, None, :, :], axes=(1, 2))
        kf_f = (lambda x, axes=(-2,-1): torch.fft.rfft2(x.float(), dim=axes))(kf_pad[:, None, :], axes=(1, 2))
        kf_f = (lambda x, *d: x.permute(*d))(kf_f, 1, 2, 0)
        y_f = kv_f * kf_f[None, :, :, :]
        y = (lambda x, s, axes=(-2,-1): torch.fft.irfft2(x, s=s, dim=axes).to(torch.bfloat16))(y_f, (1, L), axes=(1, 2))[:, 0, :S, :]
        y = y + kv * ssm_D[None, None, :]
        return q * y

    def _B_ref(x, wq, wk, wv, wo):
        B, S, D = x.shape
        H = 32
        Dh = D // H
        q = (lambda x, *d: x.permute(*d))((x @ wq).reshape(B, S, H, Dh), 0, 2, 1, 3)
        k = x @ wk
        v = x @ wv
        scores = torch.einsum("bhqd,bkd->bhqk", q, k) * (Dh ** -0.5)
        p = _softmax(scores, axis=-1)
        o = torch.einsum("bhqk,bkd->bhqd", p, v)
        return (lambda x, *d: x.permute(*d))(o, 0, 2, 1, 3).reshape(B, S, H * Dh) @ wo

    a = _A_ref(A_q, A_k, A_v, A_shift_k, A_ssm_k, A_ssm_D)
    b = _B_ref(B_x, B_wq, B_wk, B_wv, B_wo)
    return torch.concatenate([a, b], axis=-1)
```

```asm
; @launch grid=(256,1,1) block=(1024,1,1) lds=163840
.amdgcn_target "amdgcn-amd-amdhsa--gfx950"
.text
.globl concat_heads__ssm_conv_h3__grouped_kv_mqa__prompt_kernel
.p2align 8
.type concat_heads__ssm_conv_h3__grouped_kv_mqa__prompt_kernel,@function
concat_heads__ssm_conv_h3__grouped_kv_mqa__prompt_kernel:
  s_cmp_ge_u32 s2, 256
  s_cbranch_scc1 L_END
  s_load_dwordx4 s[8:11], s[0:1], 48
  s_load_dwordx4 s[12:15], s[0:1], 64
  s_load_dwordx4 s[4:7], s[0:1], 96
  v_lshrrev_b32 v1, 6, v0
  v_and_b32 v2, 63, v0
  s_and_b32 s3, s2, 7
  v_readfirstlane_b32 s18, v1
  s_lshr_b32 s19, s2, 3
  s_and_b32 s17, s19, 7
  s_lshr_b32 s20, s19, 3
  s_lshl_b32 s16, s3, 2
  s_add_u32 s16, s16, s20
  v_and_b32 v1, 31, v2
  v_lshrrev_b32 v3, 5, v2
  v_mov_b32 v125, 161280
  v_mov_b32 v126, 1
  s_cmp_ge_u32 s18, 8
  s_cbranch_scc1 L_ATT
  s_setprio 3
  s_cmp_ge_u32 s18, 4
  s_cbranch_scc1 L_LW
  s_cmp_eq_u32 s18, 3
  s_cbranch_scc1 L_LOADER
  s_cmp_ge_u32 s17, 4
  s_cbranch_scc1 L_NOWKV
  v_lshrrev_b32 v41, 3, v2
  v_mul_u32_u24 v40, 1152, v41
  v_and_b32 v41, 7, v2
  v_lshrrev_b32 v42, 4, v2
  v_xor_b32 v41, v41, v42
  v_lshl_add_u32 v40, v41, 4, v40
  v_xor_b32 v41, 64, v40
  s_and_b32 s21, s17, 1
  s_lshl_b32 s22, s16, 1
  s_add_u32 s22, s22, s21
  s_mul_i32 s22, s22, 36864
  s_mul_i32 s23, s18, 384
  s_add_u32 s36, s22, s23
  s_mul_i32 s37, s18, 24576
  s_lshl_b32 s23, s21, 12
  s_add_u32 s37, s37, s23
  s_add_u32 s37, s37, 23040
  s_movk_i32 s22, 6554
  v_add_u32 v6, 0, v2
  v_mul_u32_u24 v7, s22, v6
  v_lshrrev_b32 v7, 16, v7
  v_sub_u32 v7, v2, v7
  v_lshl_add_u32 v8, v7, 2, 64
  v_add_u32 v8, 192, v8
  v_add_u32 v6, 64, v2
  v_mul_u32_u24 v7, s22, v6
  v_lshrrev_b32 v7, 16, v7
  v_sub_u32 v7, v2, v7
  v_lshl_add_u32 v9, v7, 2, 64
  v_add_u32 v9, 192, v9
  v_add_u32 v6, 128, v2
  v_mul_u32_u24 v7, s22, v6
  v_lshrrev_b32 v7, 16, v7
  v_sub_u32 v7, v2, v7
  v_lshl_add_u32 v10, v7, 2, 64
  v_add_u32 v10, 192, v10
  v_add_u32 v6, 192, v2
  v_mul_u32_u24 v7, s22, v6
  v_lshrrev_b32 v7, 16, v7
  v_sub_u32 v7, v2, v7
  v_lshl_add_u32 v11, v7, 2, 64
  v_add_u32 v11, 192, v11
  v_add_u32 v6, 256, v2
  v_mul_u32_u24 v7, s22, v6
  v_lshrrev_b32 v7, 16, v7
  v_sub_u32 v7, v2, v7
  v_lshl_add_u32 v12, v7, 2, 64
  v_add_u32 v12, 192, v12
  s_mul_i32 s22, s18, 6912
  s_sub_u32 s22, s22, 256
  s_ashr_i32 s39, s22, 31
  s_mul_i32 s23, s18, 7680
  s_mul_i32 s38, s18, 24576
  v_bfe_u32 v43, v1, 1, 3
  v_xor_b32 v43, v43, v3
  v_lshlrev_b32 v44, 4, v43
  v_lshl_add_u32 v44, v1, 7, v44
  s_lshl_b32 s60, s21, 12
  s_add_u32 s60, s60, 23040
  v_add_u32 v44, s60, v44
  v_xor_b32 v45, 32, v44
  v_xor_b32 v46, 64, v44
  v_xor_b32 v47, 96, v44
  v_add_u32 v44, s38, v44
  v_add_u32 v45, s38, v45
  v_add_u32 v46, s38, v46
  v_add_u32 v47, s38, v47
  s_waitcnt lgkmcnt(0)
  s_cmp_ge_u32 s17, 2
  s_cselect_b32 s24, s14, s12
  s_cselect_b32 s25, s15, s13
  s_add_u32 s24, s24, s22
  s_addc_u32 s25, s25, s39
  s_mov_b32 s26, 7168
  s_mov_b32 s27, 0x20000
  s_add_u32 s28, s8, s36
  s_addc_u32 s29, s9, 0
  s_mov_b32 s30, 36096
  s_mov_b32 s31, 0x20000
  s_add_u32 m0, s37, 0
  s_mov_b32 s38, 0
  buffer_load_dwordx4 v40, s[28:31], s38 offen lds
  s_add_u32 m0, s37, 1024
  s_mov_b32 s38, 9216
  buffer_load_dwordx4 v41, s[28:31], s38 offen lds
  s_add_u32 m0, s37, 2048
  s_mov_b32 s38, 18432
  buffer_load_dwordx4 v40, s[28:31], s38 offen lds
  s_add_u32 m0, s37, 3072
  s_mov_b32 s38, 27648
  buffer_load_dwordx4 v41, s[28:31], s38 offen lds
  s_add_u32 m0, s23, 0
  s_movk_i32 s38, 0
  buffer_load_dword v8, s[24:27], s38 offen offset:0 lds
  buffer_load_dword v9, s[24:27], s38 offen offset:256 lds
  buffer_load_dword v10, s[24:27], s38 offen offset:512 lds
  buffer_load_dword v11, s[24:27], s38 offen offset:768 lds
  buffer_load_dword v12, s[24:27], s38 offen offset:1024 lds
  s_add_u32 m0, s23, 1280
  s_movk_i32 s38, 1152
  buffer_load_dword v8, s[24:27], s38 offen offset:0 lds
  buffer_load_dword v9, s[24:27], s38 offen offset:256 lds
  buffer_load_dword v10, s[24:27], s38 offen offset:512 lds
  buffer_load_dword v11, s[24:27], s38 offen offset:768 lds
  buffer_load_dword v12, s[24:27], s38 offen offset:1024 lds
  s_add_u32 m0, s37, 8192
  s_mov_b32 s38, 128
  buffer_load_dwordx4 v40, s[28:31], s38 offen lds
  s_add_u32 m0, s37, 9216
  s_mov_b32 s38, 9344
  buffer_load_dwordx4 v41, s[28:31], s38 offen lds
  s_add_u32 m0, s37, 10240
  s_mov_b32 s38, 18560
  buffer_load_dwordx4 v40, s[28:31], s38 offen lds
  s_add_u32 m0, s37, 11264
  s_mov_b32 s38, 27776
  buffer_load_dwordx4 v41, s[28:31], s38 offen lds
  s_add_u32 m0, s23, 2560
  s_movk_i32 s38, 2304
  buffer_load_dword v8, s[24:27], s38 offen offset:0 lds
  buffer_load_dword v9, s[24:27], s38 offen offset:256 lds
  buffer_load_dword v10, s[24:27], s38 offen offset:512 lds
  buffer_load_dword v11, s[24:27], s38 offen offset:768 lds
  buffer_load_dword v12, s[24:27], s38 offen offset:1024 lds
  s_add_u32 m0, s23, 3840
  s_movk_i32 s38, 3456
  buffer_load_dword v8, s[24:27], s38 offen offset:0 lds
  buffer_load_dword v9, s[24:27], s38 offen offset:256 lds
  buffer_load_dword v10, s[24:27], s38 offen offset:512 lds
  buffer_load_dword v11, s[24:27], s38 offen offset:768 lds
  buffer_load_dword v12, s[24:27], s38 offen offset:1024 lds
  s_add_u32 m0, s37, 16384
  s_mov_b32 s38, 256
  buffer_load_dwordx4 v40, s[28:31], s38 offen lds
  s_add_u32 m0, s37, 17408
  s_mov_b32 s38, 9472
  buffer_load_dwordx4 v41, s[28:31], s38 offen lds
  s_add_u32 m0, s37, 18432
  s_mov_b32 s38, 18688
  buffer_load_dwordx4 v40, s[28:31], s38 offen lds
  s_add_u32 m0, s37, 19456
  s_mov_b32 s38, 27904
  buffer_load_dwordx4 v41, s[28:31], s38 offen lds
  s_add_u32 m0, s23, 5120
  s_movk_i32 s38, 4608
  buffer_load_dword v8, s[24:27], s38 offen offset:0 lds
  buffer_load_dword v9, s[24:27], s38 offen offset:256 lds
  buffer_load_dword v10, s[24:27], s38 offen offset:512 lds
  buffer_load_dword v11, s[24:27], s38 offen offset:768 lds
  buffer_load_dword v12, s[24:27], s38 offen offset:1024 lds
  s_add_u32 m0, s23, 6400
  s_movk_i32 s38, 5760
  buffer_load_dword v8, s[24:27], s38 offen offset:0 lds
  buffer_load_dword v9, s[24:27], s38 offen offset:256 lds
  buffer_load_dword v10, s[24:27], s38 offen offset:512 lds
  buffer_load_dword v11, s[24:27], s38 offen offset:768 lds
  buffer_load_dword v12, s[24:27], s38 offen offset:1024 lds
  s_barrier
  s_mov_b32 s4, s6
  s_mov_b32 s5, s7
  v_bfe_u32 v49, v2, 2, 2
  v_lshl_add_u32 v49, v3, 3, v49
  v_mul_u32_u24 v48, 40, v49
  v_bfe_u32 v49, v2, 4, 1
  v_bfe_u32 v50, v2, 1, 1
  v_lshl_add_u32 v49, v49, 1, v50
  v_and_b32 v50, 1, v2
  v_lshlrev_b32 v50, 4, v50
  v_lshl_add_u32 v50, v49, 3, v50
  v_cmp_lt_u32 vcc, 1, v49
  v_lshlrev_b32 v53, 4, v2
  v_add_u32 v57, s23, v53
  v_cndmask_b32 v50, v50, 32, vcc
  v_add3_u32 v48, v48, v50, s23
  s_mul_i32 s22, s16, 4736
  s_add_u32 s24, s4, s22
  s_addc_u32 s25, s5, 0
  s_mov_b32 s26, 4736
  s_mov_b32 s27, 0x20000
  s_add_u32 s28, s4, 196608
  s_addc_u32 s29, s5, 0
  s_mov_b32 s30, 65536
  s_mov_b32 s31, 0x20000
  v_and_b32 v52, 0x13, v1
  v_and_b32 v54, 4, v1
  v_lshl_or_b32 v52, v54, 1, v52
  v_and_b32 v54, 8, v1
  v_lshrrev_b32 v54, 1, v54
  v_or_b32 v52, v52, v54
  s_waitcnt vmcnt(28)
  ds_read_b128 v[64:67], v44 offset:0
  ds_read_b64_tr_b16 v[68:69], v48 offset:0
  ds_read_b64_tr_b16 v[70:71], v48 offset:160
  ds_read_b128 v[72:75], v45 offset:0
  ds_read_b64_tr_b16 v[76:77], v48 offset:640
  ds_read_b64_tr_b16 v[78:79], v48 offset:800
  ds_read_b128 v[80:83], v46 offset:0
  ds_read_b64_tr_b16 v[84:85], v48 offset:1280
  ds_read_b64_tr_b16 v[86:87], v48 offset:1440
  ds_read_b128 v[88:91], v47 offset:0
  ds_read_b64_tr_b16 v[92:93], v48 offset:1920
  ds_read_b64_tr_b16 v[94:95], v48 offset:2080
  s_cmp_ge_u32 s17, 2
  s_cbranch_scc1 L_VP
  s_waitcnt vmcnt(14)
  ds_read_b128 v[96:99], v44 offset:8192
  ds_read_b64_tr_b16 v[100:101], v48 offset:2560
  ds_read_b64_tr_b16 v[102:103], v48 offset:2720
  s_waitcnt lgkmcnt(12)
  v_mfma_f32_32x32x16_bf16 v[8:23], v[68:71], v[64:67], 0
  ds_read_b128 v[64:67], v45 offset:8192
  ds_read_b64_tr_b16 v[68:69], v48 offset:3200
  ds_read_b64_tr_b16 v[70:71], v48 offset:3360
  s_waitcnt lgkmcnt(12)
  v_mfma_f32_32x32x16_bf16 v[8:23], v[76:79], v[72:75], v[8:23]
  ds_read_b128 v[72:75], v46 offset:8192
  ds_read_b64_tr_b16 v[76:77], v48 offset:3840
  ds_read_b64_tr_b16 v[78:79], v48 offset:4000
  s_waitcnt lgkmcnt(12)
  v_mfma_f32_32x32x16_bf16 v[8:23], v[84:87], v[80:83], v[8:23]
  ds_read_b128 v[80:83], v47 offset:8192
  ds_read_b64_tr_b16 v[84:85], v48 offset:4480
  ds_read_b64_tr_b16 v[86:87], v48 offset:4640
  s_waitcnt lgkmcnt(12)
  v_mfma_f32_32x32x16_bf16 v[8:23], v[92:95], v[88:91], v[8:23]
  s_waitcnt vmcnt(0)
  s_mov_b64 exec, 1
  ds_add_u32 v125, v126 offset:0
  s_mov_b64 exec, -1
  ds_read_b128 v[88:91], v44 offset:16384
  ds_read_b64_tr_b16 v[92:93], v48 offset:5120
  ds_read_b64_tr_b16 v[94:95], v48 offset:5280
  s_waitcnt lgkmcnt(12)
  v_mfma_f32_32x32x16_bf16 v[8:23], v[100:103], v[96:99], v[8:23]
  ds_read_b128 v[96:99], v45 offset:16384
  ds_read_b64_tr_b16 v[100:101], v48 offset:5760
  ds_read_b64_tr_b16 v[102:103], v48 offset:5920
  s_waitcnt lgkmcnt(12)
  v_mfma_f32_32x32x16_bf16 v[8:23], v[68:71], v[64:67], v[8:23]
  ds_read_b128 v[64:67], v46 offset:16384
  ds_read_b64_tr_b16 v[68:69], v48 offset:6400
  ds_read_b64_tr_b16 v[70:71], v48 offset:6560
  s_waitcnt lgkmcnt(12)
  v_mfma_f32_32x32x16_bf16 v[8:23], v[76:79], v[72:75], v[8:23]
  ds_read_b128 v[72:75], v47 offset:16384
  ds_read_b64_tr_b16 v[76:77], v48 offset:7040
  ds_read_b64_tr_b16 v[78:79], v48 offset:7200
  s_waitcnt lgkmcnt(12)
  v_mfma_f32_32x32x16_bf16 v[8:23], v[84:87], v[80:83], v[8:23]
  s_waitcnt lgkmcnt(9)
  v_mfma_f32_32x32x16_bf16 v[8:23], v[92:95], v[88:91], v[8:23]
  s_waitcnt lgkmcnt(6)
  v_mfma_f32_32x32x16_bf16 v[8:23], v[100:103], v[96:99], v[8:23]
  s_waitcnt lgkmcnt(3)
  v_mfma_f32_32x32x16_bf16 v[8:23], v[68:71], v[64:67], v[8:23]
  s_waitcnt lgkmcnt(0)
  v_mfma_f32_32x32x16_bf16 v[8:23], v[76:79], v[72:75], v[8:23]
  s_branch L_KVRED
L_VP:
  s_waitcnt vmcnt(14)
  ds_read_b128 v[96:99], v44 offset:8192
  ds_read_b64_tr_b16 v[100:101], v48 offset:2560
  ds_read_b64_tr_b16 v[102:103], v48 offset:2720
  s_waitcnt lgkmcnt(12)
  v_mfma_f32_32x32x16_bf16 v[8:23], v[64:67], v[68:71], 0
  ds_read_b128 v[64:67], v45 offset:8192
  ds_read_b64_tr_b16 v[68:69], v48 offset:3200
  ds_read_b64_tr_b16 v[70:71], v48 offset:3360
  s_waitcnt lgkmcnt(12)
  v_mfma_f32_32x32x16_bf16 v[8:23], v[72:75], v[76:79], v[8:23]
  ds_read_b128 v[72:75], v46 offset:8192
  ds_read_b64_tr_b16 v[76:77], v48 offset:3840
  ds_read_b64_tr_b16 v[78:79], v48 offset:4000
  s_waitcnt lgkmcnt(12)
  v_mfma_f32_32x32x16_bf16 v[8:23], v[80:83], v[84:87], v[8:23]
  ds_read_b128 v[80:83], v47 offset:8192
  ds_read_b64_tr_b16 v[84:85], v48 offset:4480
  ds_read_b64_tr_b16 v[86:87], v48 offset:4640
  s_waitcnt lgkmcnt(12)
  v_mfma_f32_32x32x16_bf16 v[8:23], v[88:91], v[92:95], v[8:23]
  s_waitcnt vmcnt(0)
  s_mov_b64 exec, 1
  ds_add_u32 v125, v126 offset:0
  s_mov_b64 exec, -1
  ds_read_b128 v[88:91], v44 offset:16384
  ds_read_b64_tr_b16 v[92:93], v48 offset:5120
  ds_read_b64_tr_b16 v[94:95], v48 offset:5280
  s_waitcnt lgkmcnt(12)
  v_mfma_f32_32x32x16_bf16 v[8:23], v[96:99], v[100:103], v[8:23]
  ds_read_b128 v[96:99], v45 offset:16384
  ds_read_b64_tr_b16 v[100:101], v48 offset:5760
  ds_read_b64_tr_b16 v[102:103], v48 offset:5920
  s_waitcnt lgkmcnt(12)
  v_mfma_f32_32x32x16_bf16 v[8:23], v[64:67], v[68:71], v[8:23]
  ds_read_b128 v[64:67], v46 offset:16384
  ds_read_b64_tr_b16 v[68:69], v48 offset:6400
  ds_read_b64_tr_b16 v[70:71], v48 offset:6560
  s_waitcnt lgkmcnt(12)
  v_mfma_f32_32x32x16_bf16 v[8:23], v[72:75], v[76:79], v[8:23]
  ds_read_b128 v[72:75], v47 offset:16384
  ds_read_b64_tr_b16 v[76:77], v48 offset:7040
  ds_read_b64_tr_b16 v[78:79], v48 offset:7200
  s_waitcnt lgkmcnt(12)
  v_mfma_f32_32x32x16_bf16 v[8:23], v[80:83], v[84:87], v[8:23]
  s_waitcnt lgkmcnt(9)
  v_mfma_f32_32x32x16_bf16 v[8:23], v[88:91], v[92:95], v[8:23]
  s_waitcnt lgkmcnt(6)
  v_mfma_f32_32x32x16_bf16 v[8:23], v[96:99], v[100:103], v[8:23]
  s_waitcnt lgkmcnt(3)
  v_mfma_f32_32x32x16_bf16 v[8:23], v[64:67], v[68:71], v[8:23]
  s_waitcnt lgkmcnt(0)
  v_mfma_f32_32x32x16_bf16 v[8:23], v[72:75], v[76:79], v[8:23]
L_KVRED:
  s_cmp_eq_u32 s18, 0
  s_cbranch_scc1 L_KVH0
  s_nop 9
  ds_write_b128 v57, v[8:11] offset:0
  ds_write_b128 v57, v[12:15] offset:1024
  ds_write_b128 v57, v[16:19] offset:2048
  ds_write_b128 v57, v[20:23] offset:3072
  s_mov_b64 exec, 1
  ds_add_u32 v125, v126 offset:44
  s_mov_b64 exec, -1
  s_branch L_EPI
L_KVH0:
  s_nop 3
LW_1:
  ds_read_b32 v127, v125 offset:44
  s_waitcnt lgkmcnt(0)
  v_readfirstlane_b32 s60, v127
  s_cmp_ge_u32 s60, 2
  s_cbranch_scc0 LW_1
  ds_read_b128 v[64:67], v53 offset:7680
  ds_read_b128 v[68:71], v53 offset:8704
  ds_read_b128 v[72:75], v53 offset:9728
  ds_read_b128 v[76:79], v53 offset:10752
  ds_read_b128 v[80:83], v53 offset:15360
  ds_read_b128 v[84:87], v53 offset:16384
  ds_read_b128 v[88:91], v53 offset:17408
  ds_read_b128 v[92:95], v53 offset:18432
  s_waitcnt lgkmcnt(4)
  v_pk_add_f32 v[8:9], v[8:9], v[64:65]
  v_pk_add_f32 v[10:11], v[10:11], v[66:67]
  v_pk_add_f32 v[12:13], v[12:13], v[68:69]
  v_pk_add_f32 v[14:15], v[14:15], v[70:71]
  v_pk_add_f32 v[16:17], v[16:17], v[72:73]
  v_pk_add_f32 v[18:19], v[18:19], v[74:75]
  v_pk_add_f32 v[20:21], v[20:21], v[76:77]
  v_pk_add_f32 v[22:23], v[22:23], v[78:79]
  s_waitcnt lgkmcnt(0)
  v_pk_add_f32 v[8:9], v[8:9], v[80:81]
  v_pk_add_f32 v[10:11], v[10:11], v[82:83]
  v_pk_add_f32 v[12:13], v[12:13], v[84:85]
  v_pk_add_f32 v[14:15], v[14:15], v[86:87]
  v_pk_add_f32 v[16:17], v[16:17], v[88:89]
  v_pk_add_f32 v[18:19], v[18:19], v[90:91]
  v_pk_add_f32 v[20:21], v[20:21], v[92:93]
  v_pk_add_f32 v[22:23], v[22:23], v[94:95]
  s_cmp_ge_u32 s17, 2
  s_cbranch_scc1 L_VPROJ
  s_lshl_b32 s23, s21, 10
  v_lshlrev_b32 v54, 4, v52
  v_lshl_add_u32 v54, v3, 9, v54
  s_lshl_b32 s22, s21, 7
  s_add_u32 s22, s22, 2048
  v_lshlrev_b32 v55, 2, v52
  v_cmp_eq_u32 vcc, 0, v3
  v_mov_b32 v61, 0
  v_cvt_pk_bf16_f32 v24, v8, v9
  v_cvt_pk_bf16_f32 v25, v10, v11
  v_cvt_pk_bf16_f32 v26, v12, v13
  v_cvt_pk_bf16_f32 v27, v14, v15
  v_cvt_pk_bf16_f32 v28, v16, v17
  buffer_store_dwordx4 v[24:27], v54, s[24:27], s23 offen sc1
  s_mov_b32 exec_hi, 0
  buffer_store_dword v28, v55, s[24:27], s22 offen sc1
  s_mov_b32 exec_hi, -1
  v_cndmask_b32 v56, 0, v28, vcc
  v_dot2_f32_bf16 v61, v24, v24, v61
  v_dot2_f32_bf16 v61, v25, v25, v61
  v_dot2_f32_bf16 v61, v26, v26, v61
  v_dot2_f32_bf16 v61, v27, v27, v61
  v_dot2_f32_bf16 v61, v56, v56, v61
  s_nop 2
  v_mov_b32 v56, v61
  s_nop 1
  v_permlane32_swap_b32 v61, v56
  s_nop 1
  v_add_f32 v61, v61, v56
  s_nop 1
  v_max_u32_dpp v61, v61, v61 row_ror:8 row_mask:0xf bank_mask:0xf
  s_nop 1
  v_max_u32_dpp v61, v61, v61 row_ror:4 row_mask:0xf bank_mask:0xf
  s_nop 1
  v_max_u32_dpp v61, v61, v61 row_ror:2 row_mask:0xf bank_mask:0xf
  s_nop 1
  v_max_u32_dpp v61, v61, v61 row_ror:1 row_mask:0xf bank_mask:0xf
  s_nop 0
  v_readlane_b32 s22, v61, 0
  v_readlane_b32 s23, v61, 16
  s_max_u32 s22, s22, s23
  s_branch L_KVFLAG
L_VPROJ:
  s_mul_i32 s23, s21, 1216
  s_add_u32 s23, s23, 2304
  v_mul_u32_u24 v54, 304, v3
  v_lshl_add_u32 v54, v1, 4, v54
  v_cmp_eq_u32 vcc, 18, v1
  v_mov_b32 v55, 0x3f803f80
  v_cmp_gt_u32 s[40:41], 19, v1
  v_cvt_pk_bf16_f32 v24, v8, v9
  v_cvt_pk_bf16_f32 v25, v10, v11
  v_cvt_pk_bf16_f32 v26, v12, v13
  v_cvt_pk_bf16_f32 v27, v14, v15
  v_cvt_pk_bf16_f32 v28, v16, v17
  v_cvt_pk_bf16_f32 v29, v18, v19
  v_cvt_pk_bf16_f32 v30, v20, v21
  v_cvt_pk_bf16_f32 v31, v22, v23
  v_cndmask_b32 v24, v24, v55, vcc
  v_cndmask_b32 v25, v25, v55, vcc
  v_cndmask_b32 v26, v26, v55, vcc
  v_cndmask_b32 v27, v27, v55, vcc
  v_cndmask_b32 v28, v28, v55, vcc
  v_cndmask_b32 v29, v29, v55, vcc
  v_cndmask_b32 v30, v30, v55, vcc
  v_cndmask_b32 v31, v31, v55, vcc
  s_mov_b64 exec, s[40:41]
  buffer_store_dwordx4 v[24:27], v54, s[24:27], s23 offen sc1
  buffer_store_dwordx4 v[28:31], v54, s[24:27], s23 offen offset:608 sc1
  s_mov_b64 exec, -1
  s_mov_b32 s22, 0
L_KVFLAG:
LW_2:
  ds_read_b32 v127, v125 offset:52
  s_waitcnt lgkmcnt(0)
  v_readfirstlane_b32 s61, v127
  s_cmp_ge_u32 s61, 1
  s_cbranch_scc1 LW_2_d
  s_sleep 1
  s_branch LW_2
LW_2_d:
  s_lshl_b32 s23, s16, 2
  s_add_u32 s23, s23, s17
  s_lshl_b32 s23, s23, 4
  v_lshlrev_b32 v56, 11, v2
  v_mov_b32 v58, s61
  v_mov_b32 v59, s22
  s_mov_b32 exec_lo, 255
  s_mov_b32 exec_hi, 0
  s_waitcnt vmcnt(0)
  buffer_store_dwordx2 v[58:59], v56, s[28:31], s23 offen sc1
  s_endpgm
L_NOWKV:
  s_waitcnt lgkmcnt(0)
  s_mov_b32 s4, s6
  s_mov_b32 s5, s7
  s_barrier
  s_mov_b64 exec, 1
  ds_add_u32 v125, v126 offset:0
  s_mov_b64 exec, -1
  s_cmp_lg_u32 s18, 0
  s_cbranch_scc1 L_EPI
  s_cmp_ge_u32 s17, 6
  s_cbranch_scc1 L_EPI
  s_endpgm
L_EPI:
  s_load_dwordx2 s[8:9], s[0:1], 0
  s_load_dwordx2 s[10:11], s[0:1], 88
  s_sub_u32 s21, s18, 1
  s_lshl_b32 s21, s21, 5
  s_add_u32 s21, s21, s19
  s_lshl_b32 s22, s20, 1
  s_add_u32 s22, s22, s17
  s_add_u32 s22, s22, 58
  s_cmp_eq_u32 s18, 0
  s_cselect_b32 s21, s22, s21
  s_mul_i32 s22, s3, 72
  s_add_u32 s21, s21, s22
  s_lshr_b32 s22, s21, 6
  s_and_b32 s23, s21, 63
LW_3:
  ds_read_b32 v127, v125 offset:52
  s_waitcnt lgkmcnt(0)
  v_readfirstlane_b32 s61, v127
  s_cmp_ge_u32 s61, 1
  s_cbranch_scc1 LW_3_d
  s_sleep 24
  s_branch LW_3
LW_3_d:
  s_add_u32 s52, s4, 335872
  s_addc_u32 s53, s5, 0
  s_mov_b32 s54, 32768
  s_mov_b32 s55, 0x20000
  v_lshlrev_b32 v110, 4, v2
  s_lshl_b32 s57, s22, 2
  s_cmp_lg_u32 s23, 0
  s_cbranch_scc1 L_NOAGG1
  s_lshl_b32 s37, s22, 11
  s_add_u32 s37, s37, 393216
  s_add_u32 s24, s4, s37
  s_addc_u32 s25, s5, 0
  s_mov_b32 s26, 2048
  s_mov_b32 s27, 0x20000
LW_4:
  ds_read_b32 v127, v125 offset:64
  s_waitcnt lgkmcnt(0)
  v_readfirstlane_b32 s60, v127
  s_cmp_ge_u32 s60, 4
  s_cbranch_scc1 LW_4_d
  s_sleep 4
  s_branch LW_4
LW_4_d:
  s_mov_b32 s62, 0
GP_5:
  buffer_load_dword v127, v110, s[24:27], 0 offen offset:0 sc1
  s_add_u32 s62, s62, 1
  s_waitcnt vmcnt(0)
  v_cmp_ne_u32 vcc, s61, v127
  s_cmp_eq_u64 vcc, 0
  s_cbranch_scc1 GP_5_d
  s_mov_b64 exec, vcc
  s_cmp_ge_u32 s62, 32768
  s_cbranch_scc1 GP_5_d
  s_sleep 2
  s_branch GP_5
GP_5_d:
  s_mov_b64 exec, -1
  s_mov_b32 s62, 0
GP_6:
  buffer_load_dword v127, v110, s[24:27], 0 offen offset:1024 sc1
  s_add_u32 s62, s62, 1
  s_waitcnt vmcnt(0)
  v_cmp_ne_u32 vcc, s61, v127
  s_cmp_eq_u64 vcc, 0
  s_cbranch_scc1 GP_6_d
  s_mov_b64 exec, vcc
  s_cmp_ge_u32 s62, 32768
  s_cbranch_scc1 GP_6_d
  s_sleep 2
  s_branch GP_6
GP_6_d:
  s_mov_b64 exec, -1
  s_mul_i32 s58, s22, 58255
  s_lshr_b32 s58, s58, 16
  v_lshlrev_b32 v111, 3, v1
  v_add3_u32 v111, v111, v3, s58
  v_lshlrev_b32 v111, 7, v111
  v_mov_b32 v127, s61
  s_cmp_eq_u32 s58, 7
  s_cselect_b32 exec_hi, 0, -1
  buffer_store_dword v127, v111, s[52:55], s57 offen sc1
  s_mov_b32 exec_hi, -1
L_NOAGG1:
  s_mov_b64 exec, 1
  ds_add_u32 v125, v126 offset:124
  s_mov_b64 exec, -1
  s_lshl_b32 s37, s22, 11
  s_add_u32 s37, s37, 311296
  s_add_u32 s24, s4, s37
  s_addc_u32 s25, s5, 0
  s_mov_b32 s26, 2048
  s_mov_b32 s27, 0x20000
  s_bfe_u32 s56, s23, 0x10005
  s_lshr_b32 s38, s23, 4
  s_lshl_b32 s38, s38, 9
  s_bfe_u32 s37, s23, 0x10003
  s_lshl_b32 s37, s37, 2
  s_add_u32 s38, s38, s37
  s_and_b32 s37, s23, 7
  s_lshl_b32 s37, s37, 5
  s_add_u32 s38, s38, s37
  s_lshl_b32 s37, s22, 7
  s_mul_i32 s39, s38, 1152
  s_add_u32 s39, s39, s37
  s_mul_i32 s38, s38, 2304
  s_add_u32 s38, s38, s37
  v_mul_u32_u24 v4, 9216, v3
  v_lshl_add_u32 v4, v1, 2, v4
  v_add_u32 v4, s39, v4
  v_mul_u32_u24 v5, 18432, v3
  v_lshl_add_u32 v5, v1, 2, v5
  v_add_u32 v5, s38, v5
  v_mul_u32_u24 v6, 12288, v1
  v_lshl_add_u32 v6, v3, 4, v6
  s_lshl_b32 s37, s23, 6
  v_add_u32 v6, s37, v6
  v_add_u32 v7, 6144, v6
  s_mul_i32 s37, s22, 393216
  s_add_u32 s37, s37, 6553600
  s_add_u32 s32, s4, s37
  s_addc_u32 s33, s5, 0
  s_mov_b32 s34, 393216
  s_mov_b32 s35, 0x20000
  s_mov_b32 s40, s8
  s_mov_b32 s41, s9
  s_mov_b32 s42, 2359296
  s_mov_b32 s43, 0x20000
  s_mov_b32 s44, s10
  s_mov_b32 s45, s11
  s_mov_b32 s46, 4718592
  s_mov_b32 s47, 0x20000
LW_7:
  ds_read_b32 v127, v125 offset:68
  s_waitcnt lgkmcnt(0)
  v_readfirstlane_b32 s60, v127
  s_cmp_ge_u32 s60, 8
  s_cbranch_scc1 LW_7_d
  s_sleep 32
  s_branch LW_7
LW_7_d:
  s_mov_b32 s37, 0
  buffer_load_dword v64, v4, s[40:43], s37 offen
  s_mov_b32 s37, 1152
  buffer_load_dword v65, v4, s[40:43], s37 offen
  s_mov_b32 s37, 2304
  buffer_load_dword v66, v4, s[40:43], s37 offen
  s_mov_b32 s37, 3456
  buffer_load_dword v67, v4, s[40:43], s37 offen
  s_mov_b32 s37, 294912
  buffer_load_dword v68, v4, s[40:43], s37 offen
  s_mov_b32 s37, 296064
  buffer_load_dword v69, v4, s[40:43], s37 offen
  s_mov_b32 s37, 297216
  buffer_load_dword v70, v4, s[40:43], s37 offen
  s_mov_b32 s37, 298368
  buffer_load_dword v71, v4, s[40:43], s37 offen
  s_mov_b32 s37, 18432
  buffer_load_dword v72, v4, s[40:43], s37 offen
  s_mov_b32 s37, 19584
  buffer_load_dword v73, v4, s[40:43], s37 offen
  s_mov_b32 s37, 20736
  buffer_load_dword v74, v4, s[40:43], s37 offen
  s_mov_b32 s37, 21888
  buffer_load_dword v75, v4, s[40:43], s37 offen
  s_mov_b32 s37, 313344
  buffer_load_dword v76, v4, s[40:43], s37 offen
  s_mov_b32 s37, 314496
  buffer_load_dword v77, v4, s[40:43], s37 offen
  s_mov_b32 s37, 315648
  buffer_load_dword v78, v4, s[40:43], s37 offen
  s_mov_b32 s37, 316800
  buffer_load_dword v79, v4, s[40:43], s37 offen
LW_8:
  ds_read_b32 v127, v125 offset:96
  s_waitcnt lgkmcnt(0)
  v_readfirstlane_b32 s60, v127
  s_cmp_ge_u32 s60, 4
  s_cbranch_scc1 LW_8_d
  s_sleep 8
  s_branch LW_8
LW_8_d:
  s_add_u32 s57, s57, 64
  s_cmp_lg_u32 s23, 0
  s_cbranch_scc1 L_NOAGG2
  s_mov_b32 s62, 0
GP_9:
  buffer_load_dword v127, v110, s[24:27], 0 offen offset:0 sc1
  s_add_u32 s62, s62, 1
  s_waitcnt vmcnt(0)
  v_cmp_ne_u32 vcc, s61, v127
  s_cmp_eq_u64 vcc, 0
  s_cbranch_scc1 GP_9_d
  s_mov_b64 exec, vcc
  s_cmp_ge_u32 s62, 32768
  s_cbranch_scc1 GP_9_d
  s_sleep 2
  s_branch GP_9
GP_9_d:
  s_mov_b64 exec, -1
  s_mov_b32 s62, 0
GP_10:
  buffer_load_dword v127, v110, s[24:27], 0 offen offset:1024 sc1
  s_add_u32 s62, s62, 1
  s_waitcnt vmcnt(0)
  v_cmp_ne_u32 vcc, s61, v127
  s_cmp_eq_u64 vcc, 0
  s_cbranch_scc1 GP_10_d
  s_mov_b64 exec, vcc
  s_cmp_ge_u32 s62, 32768
  s_cbranch_scc1 GP_10_d
  s_sleep 2
  s_branch GP_10
GP_10_d:
  s_mov_b64 exec, -1
  s_mul_i32 s58, s22, 58255
  s_lshr_b32 s58, s58, 16
  v_lshlrev_b32 v111, 3, v1
  v_add3_u32 v111, v111, v3, s58
  v_lshlrev_b32 v111, 7, v111
  v_mov_b32 v127, s61
  s_cmp_eq_u32 s58, 7
  s_cselect_b32 exec_hi, 0, -1
  buffer_store_dword v127, v111, s[52:55], s57 offen sc1
  s_mov_b32 exec_hi, -1
L_NOAGG2:
  s_lshl_b32 s37, s2, 7
  s_add_u32 s37, s37, s57
  s_mov_b32 exec_lo, 1
  s_mov_b32 exec_hi, 0
  s_mov_b32 s62, 0
GP_11:
  buffer_load_dword v127, v110, s[52:55], s37 offen offset:0 sc1
  s_add_u32 s62, s62, 1
  s_waitcnt vmcnt(0)
  v_cmp_ne_u32 vcc, s61, v127
  s_cmp_eq_u64 vcc, 0
  s_cbranch_scc1 GP_11_d
  s_mov_b64 exec, vcc
  s_cmp_ge_u32 s62, 32768
  s_cbranch_scc1 GP_11_d
  s_sleep 4
  s_branch GP_11
GP_11_d:
  s_mov_b64 exec, -1
  buffer_load_dwordx4 v[8:11], v6, s[32:35], 0 offen offset:0 sc1
  buffer_load_dwordx4 v[12:15], v7, s[32:35], 0 offen offset:0 sc1
  buffer_load_dwordx4 v[16:19], v6, s[32:35], 0 offen offset:32 sc1
  buffer_load_dwordx4 v[20:23], v7, s[32:35], 0 offen offset:32 sc1
  s_mov_b32 s36, 0xffff0000
  s_mov_b32 s38, 0xffff
  s_setprio 3
  s_cmp_eq_u32 s56, 1
  s_cbranch_scc1 L_EPI2
  s_waitcnt vmcnt(2)
  v_and_b32 v32, s38, v64
  v_lshrrev_b32 v33, 16, v64
  v_lshlrev_b32 v36, 16, v65
  v_and_b32 v37, s36, v65
  v_dot2_f32_bf16 v34, v8, v32, 0
  v_dot2_f32_bf16 v35, v12, v33, 0
  v_dot2_f32_bf16 v38, v8, v36, 0
  v_dot2_f32_bf16 v39, v12, v37, 0
  s_mov_b32 s37, 0
  s_nop 1
  v_cvt_pk_bf16_f32 v64, v34, v35
  buffer_store_dword v64, v5, s[44:47], s37 offen offset:0 sc1
  v_cvt_pk_bf16_f32 v65, v38, v39
  buffer_store_dword v65, v5, s[44:47], s37 offen offset:2304 sc1
  v_and_b32 v32, s38, v66
  v_lshrrev_b32 v33, 16, v66
  v_lshlrev_b32 v36, 16, v67
  v_and_b32 v37, s36, v67
  v_dot2_f32_bf16 v34, v9, v32, 0
  v_dot2_f32_bf16 v35, v13, v33, 0
  v_dot2_f32_bf16 v38, v9, v36, 0
  v_dot2_f32_bf16 v39, v13, v37, 0
  s_mov_b32 s37, 4608
  s_nop 1
  v_cvt_pk_bf16_f32 v66, v34, v35
  buffer_store_dword v66, v5, s[44:47], s37 offen offset:0 sc1
  v_cvt_pk_bf16_f32 v67, v38, v39
  buffer_store_dword v67, v5, s[44:47], s37 offen offset:2304 sc1
  v_and_b32 v32, s38, v68
  v_lshrrev_b32 v33, 16, v68
  v_lshlrev_b32 v36, 16, v69
  v_and_b32 v37, s36, v69
  v_dot2_f32_bf16 v34, v10, v32, 0
  v_dot2_f32_bf16 v35, v14, v33, 0
  v_dot2_f32_bf16 v38, v10, v36, 0
  v_dot2_f32_bf16 v39, v14, v37, 0
  s_mov_b32 s37, 589824
  s_nop 1
  v_cvt_pk_bf16_f32 v68, v34, v35
  buffer_store_dword v68, v5, s[44:47], s37 offen offset:0 sc1
  v_cvt_pk_bf16_f32 v69, v38, v39
  buffer_store_dword v69, v5, s[44:47], s37 offen offset:2304 sc1
  v_and_b32 v32, s38, v70
  v_lshrrev_b32 v33, 16, v70
  v_lshlrev_b32 v36, 16, v71
  v_and_b32 v37, s36, v71
  v_dot2_f32_bf16 v34, v11, v32, 0
  v_dot2_f32_bf16 v35, v15, v33, 0
  v_dot2_f32_bf16 v38, v11, v36, 0
  v_dot2_f32_bf16 v39, v15, v37, 0
  s_mov_b32 s37, 594432
  s_nop 1
  v_cvt_pk_bf16_f32 v70, v34, v35
  buffer_store_dword v70, v5, s[44:47], s37 offen offset:0 sc1
  v_cvt_pk_bf16_f32 v71, v38, v39
  buffer_store_dword v71, v5, s[44:47], s37 offen offset:2304 sc1
  s_waitcnt vmcnt(8)
  v_and_b32 v32, s38, v72
  v_lshrrev_b32 v33, 16, v72
  v_lshlrev_b32 v36, 16, v73
  v_and_b32 v37, s36, v73
  v_dot2_f32_bf16 v34, v16, v32, 0
  v_dot2_f32_bf16 v35, v20, v33, 0
  v_dot2_f32_bf16 v38, v16, v36, 0
  v_dot2_f32_bf16 v39, v20, v37, 0
  s_mov_b32 s37, 36864
  s_nop 1
  v_cvt_pk_bf16_f32 v72, v34, v35
  buffer_store_dword v72, v5, s[44:47], s37 offen offset:0 sc1
  v_cvt_pk_bf16_f32 v73, v38, v39
  buffer_store_dword v73, v5, s[44:47], s37 offen offset:2304 sc1
  v_and_b32 v32, s38, v74
  v_lshrrev_b32 v33, 16, v74
  v_lshlrev_b32 v36, 16, v75
  v_and_b32 v37, s36, v75
  v_dot2_f32_bf16 v34, v17, v32, 0
  v_dot2_f32_bf16 v35, v21, v33, 0
  v_dot2_f32_bf16 v38, v17, v36, 0
  v_dot2_f32_bf16 v39, v21, v37, 0
  s_mov_b32 s37, 41472
  s_nop 1
  v_cvt_pk_bf16_f32 v74, v34, v35
  buffer_store_dword v74, v5, s[44:47], s37 offen offset:0 sc1
  v_cvt_pk_bf16_f32 v75, v38, v39
  buffer_store_dword v75, v5, s[44:47], s37 offen offset:2304 sc1
  v_and_b32 v32, s38, v76
  v_lshrrev_b32 v33, 16, v76
  v_lshlrev_b32 v36, 16, v77
  v_and_b32 v37, s36, v77
  v_dot2_f32_bf16 v34, v18, v32, 0
  v_dot2_f32_bf16 v35, v22, v33, 0
  v_dot2_f32_bf16 v38, v18, v36, 0
  v_dot2_f32_bf16 v39, v22, v37, 0
  s_mov_b32 s37, 626688
  s_nop 1
  v_cvt_pk_bf16_f32 v76, v34, v35
  buffer_store_dword v76, v5, s[44:47], s37 offen offset:0 sc1
  v_cvt_pk_bf16_f32 v77, v38, v39
  buffer_store_dword v77, v5, s[44:47], s37 offen offset:2304 sc1
  v_and_b32 v32, s38, v78
  v_lshrrev_b32 v33, 16, v78
  v_lshlrev_b32 v36, 16, v79
  v_and_b32 v37, s36, v79
  v_dot2_f32_bf16 v34, v19, v32, 0
  v_dot2_f32_bf16 v35, v23, v33, 0
  v_dot2_f32_bf16 v38, v19, v36, 0
  v_dot2_f32_bf16 v39, v23, v37, 0
  s_mov_b32 s37, 631296
  s_nop 1
  v_cvt_pk_bf16_f32 v78, v34, v35
  buffer_store_dword v78, v5, s[44:47], s37 offen offset:0 sc1
  v_cvt_pk_bf16_f32 v79, v38, v39
  buffer_store_dword v79, v5, s[44:47], s37 offen offset:2304 sc1
  s_endpgm
L_EPI2:
  buffer_load_dwordx4 v[80:83], v6, s[32:35], 0 offen offset:2048 sc1
  buffer_load_dwordx4 v[84:87], v7, s[32:35], 0 offen offset:2048 sc1
  buffer_load_dwordx4 v[88:91], v6, s[32:35], 0 offen offset:2080 sc1
  buffer_load_dwordx4 v[92:95], v7, s[32:35], 0 offen offset:2080 sc1
  s_waitcnt vmcnt(2)
  v_and_b32 v32, s38, v64
  v_lshrrev_b32 v33, 16, v64
  v_lshlrev_b32 v36, 16, v65
  v_and_b32 v37, s36, v65
  v_dot2_f32_bf16 v34, v8, v32, 0
  v_dot2_f32_bf16 v35, v12, v33, 0
  v_dot2_f32_bf16 v38, v8, v36, 0
  v_dot2_f32_bf16 v39, v12, v37, 0
  v_dot2_f32_bf16 v34, v80, v32, v34
  v_dot2_f32_bf16 v35, v84, v33, v35
  v_dot2_f32_bf16 v38, v80, v36, v38
  v_dot2_f32_bf16 v39, v84, v37, v39
  s_mov_b32 s37, 0
  s_nop 1
  v_cvt_pk_bf16_f32 v64, v34, v35
  buffer_store_dword v64, v5, s[44:47], s37 offen offset:0 sc1
  v_cvt_pk_bf16_f32 v65, v38, v39
  buffer_store_dword v65, v5, s[44:47], s37 offen offset:2304 sc1
  v_and_b32 v32, s38, v66
  v_lshrrev_b32 v33, 16, v66
  v_lshlrev_b32 v36, 16, v67
  v_and_b32 v37, s36, v67
  v_dot2_f32_bf16 v34, v9, v32, 0
  v_dot2_f32_bf16 v35, v13, v33, 0
  v_dot2_f32_bf16 v38, v9, v36, 0
  v_dot2_f32_bf16 v39, v13, v37, 0
  v_dot2_f32_bf16 v34, v81, v32, v34
  v_dot2_f32_bf16 v35, v85, v33, v35
  v_dot2_f32_bf16 v38, v81, v36, v38
  v_dot2_f32_bf16 v39, v85, v37, v39
  s_mov_b32 s37, 4608
  s_nop 1
  v_cvt_pk_bf16_f32 v66, v34, v35
  buffer_store_dword v66, v5, s[44:47], s37 offen offset:0 sc1
  v_cvt_pk_bf16_f32 v67, v38, v39
  buffer_store_dword v67, v5, s[44:47], s37 offen offset:2304 sc1
  v_and_b32 v32, s38, v68
  v_lshrrev_b32 v33, 16, v68
  v_lshlrev_b32 v36, 16, v69
  v_and_b32 v37, s36, v69
  v_dot2_f32_bf16 v34, v10, v32, 0
  v_dot2_f32_bf16 v35, v14, v33, 0
  v_dot2_f32_bf16 v38, v10, v36, 0
  v_dot2_f32_bf16 v39, v14, v37, 0
  v_dot2_f32_bf16 v34, v82, v32, v34
  v_dot2_f32_bf16 v35, v86, v33, v35
  v_dot2_f32_bf16 v38, v82, v36, v38
  v_dot2_f32_bf16 v39, v86, v37, v39
  s_mov_b32 s37, 589824
  s_nop 1
  v_cvt_pk_bf16_f32 v68, v34, v35
  buffer_store_dword v68, v5, s[44:47], s37 offen offset:0 sc1
  v_cvt_pk_bf16_f32 v69, v38, v39
  buffer_store_dword v69, v5, s[44:47], s37 offen offset:2304 sc1
  v_and_b32 v32, s38, v70
  v_lshrrev_b32 v33, 16, v70
  v_lshlrev_b32 v36, 16, v71
  v_and_b32 v37, s36, v71
  v_dot2_f32_bf16 v34, v11, v32, 0
  v_dot2_f32_bf16 v35, v15, v33, 0
  v_dot2_f32_bf16 v38, v11, v36, 0
  v_dot2_f32_bf16 v39, v15, v37, 0
  v_dot2_f32_bf16 v34, v83, v32, v34
  v_dot2_f32_bf16 v35, v87, v33, v35
  v_dot2_f32_bf16 v38, v83, v36, v38
  v_dot2_f32_bf16 v39, v87, v37, v39
  s_mov_b32 s37, 594432
  s_nop 1
  v_cvt_pk_bf16_f32 v70, v34, v35
  buffer_store_dword v70, v5, s[44:47], s37 offen offset:0 sc1
  v_cvt_pk_bf16_f32 v71, v38, v39
  buffer_store_dword v71, v5, s[44:47], s37 offen offset:2304 sc1
  s_waitcnt vmcnt(8)
  v_and_b32 v32, s38, v72
  v_lshrrev_b32 v33, 16, v72
  v_lshlrev_b32 v36, 16, v73
  v_and_b32 v37, s36, v73
  v_dot2_f32_bf16 v34, v16, v32, 0
  v_dot2_f32_bf16 v35, v20, v33, 0
  v_dot2_f32_bf16 v38, v16, v36, 0
  v_dot2_f32_bf16 v39, v20, v37, 0
  v_dot2_f32_bf16 v34, v88, v32, v34
  v_dot2_f32_bf16 v35, v92, v33, v35
  v_dot2_f32_bf16 v38, v88, v36, v38
  v_dot2_f32_bf16 v39, v92, v37, v39
  s_mov_b32 s37, 36864
  s_nop 1
  v_cvt_pk_bf16_f32 v72, v34, v35
  buffer_store_dword v72, v5, s[44:47], s37 offen offset:0 sc1
  v_cvt_pk_bf16_f32 v73, v38, v39
  buffer_store_dword v73, v5, s[44:47], s37 offen offset:2304 sc1
  v_and_b32 v32, s38, v74
  v_lshrrev_b32 v33, 16, v74
  v_lshlrev_b32 v36, 16, v75
  v_and_b32 v37, s36, v75
  v_dot2_f32_bf16 v34, v17, v32, 0
  v_dot2_f32_bf16 v35, v21, v33, 0
  v_dot2_f32_bf16 v38, v17, v36, 0
  v_dot2_f32_bf16 v39, v21, v37, 0
  v_dot2_f32_bf16 v34, v89, v32, v34
  v_dot2_f32_bf16 v35, v93, v33, v35
  v_dot2_f32_bf16 v38, v89, v36, v38
  v_dot2_f32_bf16 v39, v93, v37, v39
  s_mov_b32 s37, 41472
  s_nop 1
  v_cvt_pk_bf16_f32 v74, v34, v35
  buffer_store_dword v74, v5, s[44:47], s37 offen offset:0 sc1
  v_cvt_pk_bf16_f32 v75, v38, v39
  buffer_store_dword v75, v5, s[44:47], s37 offen offset:2304 sc1
  v_and_b32 v32, s38, v76
  v_lshrrev_b32 v33, 16, v76
  v_lshlrev_b32 v36, 16, v77
  v_and_b32 v37, s36, v77
  v_dot2_f32_bf16 v34, v18, v32, 0
  v_dot2_f32_bf16 v35, v22, v33, 0
  v_dot2_f32_bf16 v38, v18, v36, 0
  v_dot2_f32_bf16 v39, v22, v37, 0
  v_dot2_f32_bf16 v34, v90, v32, v34
  v_dot2_f32_bf16 v35, v94, v33, v35
  v_dot2_f32_bf16 v38, v90, v36, v38
  v_dot2_f32_bf16 v39, v94, v37, v39
  s_mov_b32 s37, 626688
  s_nop 1
  v_cvt_pk_bf16_f32 v76, v34, v35
  buffer_store_dword v76, v5, s[44:47], s37 offen offset:0 sc1
  v_cvt_pk_bf16_f32 v77, v38, v39
  buffer_store_dword v77, v5, s[44:47], s37 offen offset:2304 sc1
  v_and_b32 v32, s38, v78
  v_lshrrev_b32 v33, 16, v78
  v_lshlrev_b32 v36, 16, v79
  v_and_b32 v37, s36, v79
  v_dot2_f32_bf16 v34, v19, v32, 0
  v_dot2_f32_bf16 v35, v23, v33, 0
  v_dot2_f32_bf16 v38, v19, v36, 0
  v_dot2_f32_bf16 v39, v23, v37, 0
  v_dot2_f32_bf16 v34, v91, v32, v34
  v_dot2_f32_bf16 v35, v95, v33, v35
  v_dot2_f32_bf16 v38, v91, v36, v38
  v_dot2_f32_bf16 v39, v95, v37, v39
  s_mov_b32 s37, 631296
  s_nop 1
  v_cvt_pk_bf16_f32 v78, v34, v35
  buffer_store_dword v78, v5, s[44:47], s37 offen offset:0 sc1
  v_cvt_pk_bf16_f32 v79, v38, v39
  buffer_store_dword v79, v5, s[44:47], s37 offen offset:2304 sc1
  s_endpgm
L_LW:
  s_sub_u32 s18, s18, 4
  v_lshrrev_b32 v41, 3, v2
  v_mul_u32_u24 v40, 1152, v41
  v_and_b32 v41, 7, v2
  v_lshrrev_b32 v42, 4, v2
  v_xor_b32 v41, v41, v42
  v_lshl_add_u32 v40, v41, 4, v40
  v_xor_b32 v41, 64, v40
  v_add_u32 v41, 8192, v41
  s_movk_i32 s21, 7282
  s_lshl_b32 s22, s18, 7
  v_add_u32 v10, s22, v2
  v_mul_u32_u24 v11, s21, v10
  v_lshrrev_b32 v11, 16, v11
  v_mul_u32_u24 v12, 9, v11
  v_sub_u32 v12, v10, v12
  v_lshlrev_b32 v12, 4, v12
  v_and_b32 v13, 3, v11
  v_bfe_u32 v14, v11, 2, 2
  v_lshl_add_u32 v13, v13, 2, v14
  v_lshrrev_b32 v11, 4, v11
  v_lshl_add_u32 v13, v11, 4, v13
  v_mul_u32_u24 v13, 1152, v13
  v_add_u32 v42, v13, v12
  v_add_u32 v10, 64, v10
  v_mul_u32_u24 v11, s21, v10
  v_lshrrev_b32 v11, 16, v11
  v_mul_u32_u24 v12, 9, v11
  v_sub_u32 v12, v10, v12
  v_lshlrev_b32 v12, 4, v12
  v_and_b32 v13, 3, v11
  v_bfe_u32 v14, v11, 2, 2
  v_lshl_add_u32 v13, v13, 2, v14
  v_lshrrev_b32 v11, 4, v11
  v_lshl_add_u32 v13, v11, 4, v13
  v_mul_u32_u24 v13, 1152, v13
  v_add_u32 v43, v13, v12
  v_subrev_u32 v43, 1024, v43
  s_lshl_b32 s36, s20, 1
  s_add_u32 s36, s36, s17
  s_sub_u32 s37, s36, 9
  s_cmp_ge_u32 s36, 9
  s_cselect_b32 s36, s37, s36
  s_mul_i32 s22, s16, 73728
  s_mul_i32 s23, s18, 18432
  s_add_u32 s22, s22, s23
  s_lshl_b32 s47, s18, 11
  s_add_u32 s37, s47, 96768
  s_add_u32 s47, s47, 23040
  s_lshr_b32 s38, s18, 1
  s_xor_b32 s38, s38, s17
  s_and_b32 s38, s38, 5
  s_cmp_eq_u32 s38, 0
  s_cselect_b64 s[48:49], 1, -1
  s_mul_i32 s23, s17, 144
  s_sub_u32 s38, 663552, s23
  s_waitcnt lgkmcnt(0)
  s_add_u32 s24, s8, s22
  s_addc_u32 s25, s9, 0
  s_mov_b32 s26, 18432
  s_mov_b32 s27, 0x20000
  s_add_u32 s28, s10, s23
  s_addc_u32 s29, s11, 0
  s_mov_b32 s30, s38
  s_mov_b32 s31, 0x20000
  s_mov_b32 s4, s6
  s_mov_b32 s5, s7
  s_load_dwordx2 s[14:15], s[0:1], 32
  s_load_dwordx2 s[12:13], s[0:1], 40
  s_load_dwordx4 s[8:11], s[0:1], 8
  s_load_dwordx2 s[6:7], s[0:1], 24
  s_setprio 2
  s_lshl_b32 s38, s36, 13
  s_add_u32 m0, s47, s38
  s_lshl_b32 s38, s36, 7
  s_mov_b64 exec, s[48:49]
  buffer_load_dwordx4 v40, s[24:27], s38 offen lds
  buffer_load_dwordx4 v41, s[24:27], s38 offen offset:1024 lds
  s_add_u32 m0, s37, 0
  s_mul_i32 s38, s36, 73728
  s_mov_b64 exec, -1
  buffer_load_dwordx4 v42, s[28:31], s38 offen lds
  buffer_load_dwordx4 v43, s[28:31], s38 offen offset:1024 lds
  s_add_u32 s36, s36, 1
  s_cmp_eq_u32 s36, 9
  s_cselect_b32 s36, 0, s36
  s_barrier
  s_lshl_b32 s38, s36, 13
  s_add_u32 m0, s47, s38
  s_lshl_b32 s38, s36, 7
  s_mov_b64 exec, s[48:49]
  buffer_load_dwordx4 v40, s[24:27], s38 offen lds
  buffer_load_dwordx4 v41, s[24:27], s38 offen offset:1024 lds
  s_add_u32 m0, s37, 9216
  s_mul_i32 s38, s36, 73728
  s_mov_b64 exec, -1
  buffer_load_dwordx4 v42, s[28:31], s38 offen lds
  buffer_load_dwordx4 v43, s[28:31], s38 offen offset:1024 lds
  s_add_u32 s36, s36, 1
  s_cmp_eq_u32 s36, 9
  s_cselect_b32 s36, 0, s36
  s_lshl_b32 s38, s36, 13
  s_add_u32 m0, s47, s38
  s_lshl_b32 s38, s36, 7
  s_mov_b64 exec, s[48:49]
  buffer_load_dwordx4 v40, s[24:27], s38 offen lds
  buffer_load_dwordx4 v41, s[24:27], s38 offen offset:1024 lds
  s_add_u32 m0, s37, 18432
  s_mul_i32 s38, s36, 73728
  s_mov_b64 exec, -1
  buffer_load_dwordx4 v42, s[28:31], s38 offen lds
  buffer_load_dwordx4 v43, s[28:31], s38 offen offset:1024 lds
  s_add_u32 s36, s36, 1
  s_cmp_eq_u32 s36, 9
  s_cselect_b32 s36, 0, s36
  s_waitcnt vmcnt(8)
  s_mov_b64 exec, 1
  ds_add_u32 v125, v126 offset:0
  s_mov_b64 exec, -1
  s_lshl_b32 s38, s36, 13
  s_add_u32 m0, s47, s38
  s_lshl_b32 s38, s36, 7
  s_mov_b64 exec, s[48:49]
  buffer_load_dwordx4 v40, s[24:27], s38 offen lds
  buffer_load_dwordx4 v41, s[24:27], s38 offen offset:1024 lds
  s_add_u32 m0, s37, 27648
  s_mul_i32 s38, s36, 73728
  s_mov_b64 exec, -1
  buffer_load_dwordx4 v42, s[28:31], s38 offen lds
  buffer_load_dwordx4 v43, s[28:31], s38 offen offset:1024 lds
  s_add_u32 s36, s36, 1
  s_cmp_eq_u32 s36, 9
  s_cselect_b32 s36, 0, s36
  s_waitcnt vmcnt(8)
  s_mov_b64 exec, 1
  ds_add_u32 v125, v126 offset:4
  s_mov_b64 exec, -1
  s_lshl_b32 s38, s36, 13
  s_add_u32 m0, s47, s38
  s_lshl_b32 s38, s36, 7
  s_mov_b64 exec, s[48:49]
  buffer_load_dwordx4 v40, s[24:27], s38 offen lds
  buffer_load_dwordx4 v41, s[24:27], s38 offen offset:1024 lds
  s_add_u32 m0, s37, 36864
  s_mul_i32 s38, s36, 73728
  s_mov_b64 exec, -1
  buffer_load_dwordx4 v42, s[28:31], s38 offen lds
  buffer_load_dwordx4 v43, s[28:31], s38 offen offset:1024 lds
  s_add_u32 s36, s36, 1
  s_cmp_eq_u32 s36, 9
  s_cselect_b32 s36, 0, s36
  s_waitcnt vmcnt(8)
  s_mov_b64 exec, 1
  ds_add_u32 v125, v126 offset:8
  s_mov_b64 exec, -1
  s_lshl_b32 s38, s36, 13
  s_add_u32 m0, s47, s38
  s_lshl_b32 s38, s36, 7
  s_mov_b64 exec, s[48:49]
  buffer_load_dwordx4 v40, s[24:27], s38 offen lds
  buffer_load_dwordx4 v41, s[24:27], s38 offen offset:1024 lds
  s_add_u32 m0, s37, 46080
  s_mul_i32 s38, s36, 73728
  s_mov_b64 exec, -1
  buffer_load_dwordx4 v42, s[28:31], s38 offen lds
  buffer_load_dwordx4 v43, s[28:31], s38 offen offset:1024 lds
  s_add_u32 s36, s36, 1
  s_cmp_eq_u32 s36, 9
  s_cselect_b32 s36, 0, s36
  s_waitcnt vmcnt(8)
  s_mov_b64 exec, 1
  ds_add_u32 v125, v126 offset:12
  s_mov_b64 exec, -1
  s_lshl_b32 s38, s36, 13
  s_add_u32 m0, s47, s38
  s_lshl_b32 s38, s36, 7
  s_mov_b64 exec, s[48:49]
  buffer_load_dwordx4 v40, s[24:27], s38 offen lds
  buffer_load_dwordx4 v41, s[24:27], s38 offen offset:1024 lds
  s_add_u32 m0, s37, 55296
  s_mul_i32 s38, s36, 73728
  s_mov_b64 exec, -1
  buffer_load_dwordx4 v42, s[28:31], s38 offen lds
  buffer_load_dwordx4 v43, s[28:31], s38 offen offset:1024 lds
  s_add_u32 s36, s36, 1
  s_cmp_eq_u32 s36, 9
  s_cselect_b32 s36, 0, s36
  s_waitcnt vmcnt(8)
  s_mov_b64 exec, 1
  ds_add_u32 v125, v126 offset:16
  s_mov_b64 exec, -1
LW_12:
  ds_read_b32 v127, v125 offset:36
  s_waitcnt lgkmcnt(0)
  v_readfirstlane_b32 s60, v127
  s_cmp_ge_u32 s60, 8
  s_cbranch_scc1 LW_12_d
  s_sleep 1
  s_branch LW_12
LW_12_d:
  s_lshl_b32 s38, s36, 13
  s_add_u32 m0, s47, s38
  s_lshl_b32 s38, s36, 7
  s_mov_b64 exec, s[48:49]
  buffer_load_dwordx4 v40, s[24:27], s38 offen lds
  buffer_load_dwordx4 v41, s[24:27], s38 offen offset:1024 lds
  s_add_u32 m0, s37, 0
  s_mul_i32 s38, s36, 73728
  s_mov_b64 exec, -1
  buffer_load_dwordx4 v42, s[28:31], s38 offen lds
  buffer_load_dwordx4 v43, s[28:31], s38 offen offset:1024 lds
  s_add_u32 s36, s36, 1
  s_cmp_eq_u32 s36, 9
  s_cselect_b32 s36, 0, s36
  s_waitcnt vmcnt(8)
  s_mov_b64 exec, 1
  ds_add_u32 v125, v126 offset:20
  s_mov_b64 exec, -1
LW_13:
  ds_read_b32 v127, v125 offset:40
  s_waitcnt lgkmcnt(0)
  v_readfirstlane_b32 s60, v127
  s_cmp_ge_u32 s60, 8
  s_cbranch_scc1 LW_13_d
  s_sleep 1
  s_branch LW_13
LW_13_d:
  s_lshl_b32 s38, s36, 13
  s_add_u32 m0, s47, s38
  s_lshl_b32 s38, s36, 7
  s_mov_b64 exec, s[48:49]
  buffer_load_dwordx4 v40, s[24:27], s38 offen lds
  buffer_load_dwordx4 v41, s[24:27], s38 offen offset:1024 lds
  s_add_u32 m0, s37, 9216
  s_mul_i32 s38, s36, 73728
  s_mov_b64 exec, -1
  buffer_load_dwordx4 v42, s[28:31], s38 offen lds
  buffer_load_dwordx4 v43, s[28:31], s38 offen offset:1024 lds
  s_waitcnt vmcnt(8)
  s_mov_b64 exec, 1
  ds_add_u32 v125, v126 offset:24
  s_mov_b64 exec, -1
  s_waitcnt vmcnt(4)
  s_mov_b64 exec, 1
  ds_add_u32 v125, v126 offset:28
  s_mov_b64 exec, -1
  s_waitcnt vmcnt(0)
  s_mov_b64 exec, 1
  ds_add_u32 v125, v126 offset:32
  s_mov_b64 exec, -1
  s_setprio 3
  s_mov_b32 s24, s8
  s_mov_b32 s25, s9
  s_mov_b32 s26, 2359296
  s_mov_b32 s27, 0x20000
  s_mov_b32 s28, s10
  s_mov_b32 s29, s11
  s_mov_b32 s30, 2359296
  s_mov_b32 s31, 0x20000
  s_mov_b32 s32, s6
  s_mov_b32 s33, s7
  s_mov_b32 s34, 4608
  s_mov_b32 s35, 0x20000
  s_add_u32 s44, s4, 393216
  s_addc_u32 s45, s5, 0
  s_mov_b32 s46, 18432
  s_mov_b32 s47, 0x20000
  s_mul_i32 s21, s3, 36
  s_add_u32 s21, s21, s19
  s_mov_b32 s43, 4
  s_lshl_b32 s36, s18, 5
  s_sub_u32 s36, 151664, s36
  v_mul_u32_u24 v64, 288, v1
  v_lshlrev_b32 v65, 4, v3
  v_sub_u32 v64, v64, v65
  v_add_u32 v64, s36, v64
  s_mul_i32 s36, s18, 2304
  s_add_u32 s36, s36, 151552
  v_lshrrev_b32 v66, 3, v2
  v_mul_u32_u24 v65, 144, v66
  v_and_b32 v67, 7, v2
  v_lshl_add_u32 v65, v67, 4, v65
  v_add_u32 v65, s36, v65
  v_lshlrev_b32 v66, 12, v66
  v_lshl_add_u32 v66, v67, 4, v66
  s_lshl_b32 s36, s18, 16
  v_add_u32 v66, s36, v66
  s_lshr_b32 s22, s21, 5
  s_and_b32 s23, s21, 31
  s_lshl_b32 s36, s23, 2
  s_add_u32 s36, s36, s18
  s_lshl_b32 s38, s36, 4
  s_mul_i32 s36, s36, 18432
  s_lshl_b32 s37, s22, 7
  s_add_u32 s36, s36, s37
  v_mul_u32_u24 v5, 9216, v3
  v_lshl_add_u32 v5, v1, 2, v5
  v_add_u32 v5, s36, v5
  v_subrev_u32 v6, 3456, v5
  s_lshl_b32 s37, s22, 9
  v_lshlrev_b32 v7, 4, v1
  s_movk_i32 s36, 4608
  buffer_load_dwordx4 v[8:11], v7, s[32:35], s37 offen
  buffer_load_dword v28, v6, s[24:27], 0 offen offset:0
  buffer_load_dword v29, v6, s[24:27], 0 offen offset:1152
  buffer_load_dword v30, v6, s[24:27], 0 offen offset:2304
  buffer_load_dword v31, v5, s[24:27], 0 offen offset:0
  buffer_load_dword v40, v5, s[28:31], 0 offen offset:0
  buffer_load_dword v32, v5, s[24:27], 0 offen offset:1152
  buffer_load_dword v41, v5, s[28:31], 0 offen offset:1152
  buffer_load_dword v33, v5, s[24:27], 0 offen offset:2304
  buffer_load_dword v42, v5, s[28:31], 0 offen offset:2304
  buffer_load_dword v34, v5, s[24:27], 0 offen offset:3456
  buffer_load_dword v43, v5, s[28:31], 0 offen offset:3456
  buffer_load_dword v35, v5, s[24:27], s36 offen offset:0
  buffer_load_dword v44, v5, s[28:31], s36 offen offset:0
  buffer_load_dword v36, v5, s[24:27], s36 offen offset:1152
  buffer_load_dword v45, v5, s[28:31], s36 offen offset:1152
  buffer_load_dword v37, v5, s[24:27], s36 offen offset:2304
  buffer_load_dword v46, v5, s[28:31], s36 offen offset:2304
  buffer_load_dword v38, v5, s[24:27], s36 offen offset:3456
  buffer_load_dword v47, v5, s[28:31], s36 offen offset:3456
  s_lshl_b32 s36, s22, 18
  s_lshl_b32 s37, s23, 7
  s_sub_u32 s37, 3149696, s37
  s_add_u32 s36, s36, s37
  s_add_u32 s52, s4, s36
  s_addc_u32 s53, s5, 0
  s_mov_b32 s54, 258176
  s_mov_b32 s55, 0x20000
  s_lshl_b32 s36, s22, 11
  s_add_u32 s38, s38, s36
  s_mov_b32 s39, s38
  s_cmp_lt_u32 s19, 28
  s_cbranch_scc1 L_PN1
  s_add_u32 s21, s21, 4
  s_lshr_b32 s22, s21, 5
  s_and_b32 s23, s21, 31
  s_lshl_b32 s36, s23, 2
  s_add_u32 s36, s36, s18
  s_lshl_b32 s39, s36, 4
  s_mul_i32 s36, s36, 18432
  s_lshl_b32 s37, s22, 7
  s_add_u32 s36, s36, s37
  v_mul_u32_u24 v5, 9216, v3
  v_lshl_add_u32 v5, v1, 2, v5
  v_add_u32 v5, s36, v5
  v_subrev_u32 v6, 3456, v5
  s_lshl_b32 s37, s22, 9
  v_lshlrev_b32 v7, 4, v1
  s_movk_i32 s36, 4608
  buffer_load_dwordx4 v[76:79], v7, s[32:35], s37 offen
  buffer_load_dword v80, v6, s[24:27], 0 offen offset:0
  buffer_load_dword v81, v6, s[24:27], 0 offen offset:1152
  buffer_load_dword v82, v6, s[24:27], 0 offen offset:2304
  buffer_load_dword v83, v5, s[24:27], 0 offen offset:0
  buffer_load_dword v92, v5, s[28:31], 0 offen offset:0
  buffer_load_dword v84, v5, s[24:27], 0 offen offset:1152
  buffer_load_dword v93, v5, s[28:31], 0 offen offset:1152
  buffer_load_dword v85, v5, s[24:27], 0 offen offset:2304
  buffer_load_dword v94, v5, s[28:31], 0 offen offset:2304
  buffer_load_dword v86, v5, s[24:27], 0 offen offset:3456
  buffer_load_dword v95, v5, s[28:31], 0 offen offset:3456
  buffer_load_dword v87, v5, s[24:27], s36 offen offset:0
  buffer_load_dword v96, v5, s[28:31], s36 offen offset:0
  buffer_load_dword v88, v5, s[24:27], s36 offen offset:1152
  buffer_load_dword v97, v5, s[28:31], s36 offen offset:1152
  buffer_load_dword v89, v5, s[24:27], s36 offen offset:2304
  buffer_load_dword v98, v5, s[28:31], s36 offen offset:2304
  buffer_load_dword v90, v5, s[24:27], s36 offen offset:3456
  buffer_load_dword v99, v5, s[28:31], s36 offen offset:3456
  s_lshl_b32 s36, s22, 18
  s_lshl_b32 s37, s23, 7
  s_sub_u32 s37, 3149696, s37
  s_add_u32 s36, s36, s37
  s_add_u32 s40, s4, s36
  s_addc_u32 s41, s5, 0
  s_mov_b32 s42, 258176
  s_mov_b32 s43, 0x20000
  s_lshl_b32 s36, s22, 11
  s_add_u32 s39, s39, s36
L_PN1:
  s_add_u32 s48, s4, 294912
  s_addc_u32 s49, s5, 0
  s_mov_b32 s50, 4096
  s_mov_b32 s51, 0x20000
  s_getreg_b32 s36, hwreg(HW_REG_XCC_ID)
  s_lshl_b32 s57, s16, 3
  s_add_u32 s57, s57, s17
  s_lshl_b32 s57, s57, 4
  s_lshl_b32 s37, s18, 2
  s_add_u32 s57, s57, s37
  v_mov_b32 v70, s36
  v_mov_b32 v71, 0
  s_waitcnt vmcnt(0)
  s_mov_b32 s36, 0xffff0000
  v_lshlrev_b32 v12, 16, v8
  v_lshlrev_b32 v13, 16, v10
  v_and_b32 v14, s36, v8
  v_and_b32 v15, s36, v10
  v_lshlrev_b32 v16, 16, v9
  v_lshlrev_b32 v17, 16, v11
  v_and_b32 v18, s36, v9
  v_and_b32 v19, s36, v11
  v_lshlrev_b32 v20, 16, v28
  v_and_b32 v21, s36, v28
  v_lshlrev_b32 v22, 16, v29
  v_and_b32 v23, s36, v29
  v_lshlrev_b32 v24, 16, v30
  v_and_b32 v25, s36, v30
  v_lshlrev_b32 v26, 16, v31
  v_and_b32 v27, s36, v31
  v_lshlrev_b32 v48, 16, v40
  v_and_b32 v49, s36, v40
  v_pk_mul_f32 v[50:51], v[20:21], v[18:19]
  v_pk_fma_f32 v[50:51], v[22:23], v[16:17], v[50:51]
  v_pk_fma_f32 v[50:51], v[24:25], v[14:15], v[50:51]
  v_pk_fma_f32 v[50:51], v[26:27], v[12:13], v[50:51]
  v_pk_mul_f32 v[50:51], v[50:51], v[48:49]
  v_lshlrev_b32 v20, 16, v32
  v_and_b32 v21, s36, v32
  v_lshlrev_b32 v48, 16, v41
  v_and_b32 v49, s36, v41
  v_pk_mul_f32 v[52:53], v[22:23], v[18:19]
  v_pk_fma_f32 v[52:53], v[24:25], v[16:17], v[52:53]
  v_pk_fma_f32 v[52:53], v[26:27], v[14:15], v[52:53]
  v_pk_fma_f32 v[52:53], v[20:21], v[12:13], v[52:53]
  v_pk_mul_f32 v[52:53], v[52:53], v[48:49]
  v_cvt_pk_bf16_f32 v59, v52, v50
  v_cvt_pk_bf16_f32 v63, v53, v51
  v_lshlrev_b32 v22, 16, v33
  v_and_b32 v23, s36, v33
  v_lshlrev_b32 v48, 16, v42
  v_and_b32 v49, s36, v42
  v_pk_mul_f32 v[50:51], v[24:25], v[18:19]
  v_pk_fma_f32 v[50:51], v[26:27], v[16:17], v[50:51]
  v_pk_fma_f32 v[50:51], v[20:21], v[14:15], v[50:51]
  v_pk_fma_f32 v[50:51], v[22:23], v[12:13], v[50:51]
  v_pk_mul_f32 v[50:51], v[50:51], v[48:49]
  v_lshlrev_b32 v24, 16, v34
  v_and_b32 v25, s36, v34
  v_lshlrev_b32 v48, 16, v43
  v_and_b32 v49, s36, v43
  v_pk_mul_f32 v[52:53], v[26:27], v[18:19]
  v_pk_fma_f32 v[52:53], v[20:21], v[16:17], v[52:53]
  v_pk_fma_f32 v[52:53], v[22:23], v[14:15], v[52:53]
  v_pk_fma_f32 v[52:53], v[24:25], v[12:13], v[52:53]
  v_pk_mul_f32 v[52:53], v[52:53], v[48:49]
  v_cvt_pk_bf16_f32 v58, v52, v50
  v_cvt_pk_bf16_f32 v62, v53, v51
  v_lshlrev_b32 v26, 16, v35
  v_and_b32 v27, s36, v35
  v_lshlrev_b32 v48, 16, v44
  v_and_b32 v49, s36, v44
  v_pk_mul_f32 v[50:51], v[20:21], v[18:19]
  v_pk_fma_f32 v[50:51], v[22:23], v[16:17], v[50:51]
  v_pk_fma_f32 v[50:51], v[24:25], v[14:15], v[50:51]
  v_pk_fma_f32 v[50:51], v[26:27], v[12:13], v[50:51]
  v_pk_mul_f32 v[50:51], v[50:51], v[48:49]
  v_lshlrev_b32 v20, 16, v36
  v_and_b32 v21, s36, v36
  v_lshlrev_b32 v48, 16, v45
  v_and_b32 v49, s36, v45
  v_pk_mul_f32 v[52:53], v[22:23], v[18:19]
  v_pk_fma_f32 v[52:53], v[24:25], v[16:17], v[52:53]
  v_pk_fma_f32 v[52:53], v[26:27], v[14:15], v[52:53]
  v_pk_fma_f32 v[52:53], v[20:21], v[12:13], v[52:53]
  v_pk_mul_f32 v[52:53], v[52:53], v[48:49]
  v_cvt_pk_bf16_f32 v57, v52, v50
  v_cvt_pk_bf16_f32 v61, v53, v51
  v_lshlrev_b32 v22, 16, v37
  v_and_b32 v23, s36, v37
  v_lshlrev_b32 v48, 16, v46
  v_and_b32 v49, s36, v46
  v_pk_mul_f32 v[50:51], v[24:25], v[18:19]
  v_pk_fma_f32 v[50:51], v[26:27], v[16:17], v[50:51]
  v_pk_fma_f32 v[50:51], v[20:21], v[14:15], v[50:51]
  v_pk_fma_f32 v[50:51], v[22:23], v[12:13], v[50:51]
  v_pk_mul_f32 v[50:51], v[50:51], v[48:49]
  v_lshlrev_b32 v24, 16, v38
  v_and_b32 v25, s36, v38
  v_lshlrev_b32 v48, 16, v47
  v_and_b32 v49, s36, v47
  v_pk_mul_f32 v[52:53], v[26:27], v[18:19]
  v_pk_fma_f32 v[52:53], v[20:21], v[16:17], v[52:53]
  v_pk_fma_f32 v[52:53], v[22:23], v[14:15], v[52:53]
  v_pk_fma_f32 v[52:53], v[24:25], v[12:13], v[52:53]
  v_pk_mul_f32 v[52:53], v[52:53], v[48:49]
  v_cvt_pk_bf16_f32 v56, v52, v50
  v_cvt_pk_bf16_f32 v60, v53, v51
LW_14:
  ds_read_b32 v127, v125 offset:48
  s_waitcnt lgkmcnt(0)
  v_readfirstlane_b32 s60, v127
  s_cmp_ge_u32 s60, 8
  s_cbranch_scc1 LW_14_d
  s_sleep 1
  s_branch LW_14
LW_14_d:
  ds_write_b128 v64, v[56:59]
  ds_write_b128 v64, v[60:63] offset:144
  s_mov_b64 exec, 1
  ds_add_u32 v125, v126 offset:100
  s_mov_b64 exec, -1
  s_cmp_lt_u32 s19, 28
  s_cbranch_scc1 L_PN2
  v_lshlrev_b32 v12, 16, v76
  v_lshlrev_b32 v13, 16, v78
  v_and_b32 v14, s36, v76
  v_and_b32 v15, s36, v78
  v_lshlrev_b32 v16, 16, v77
  v_lshlrev_b32 v17, 16, v79
  v_and_b32 v18, s36, v77
  v_and_b32 v19, s36, v79
  v_lshlrev_b32 v20, 16, v80
  v_and_b32 v21, s36, v80
  v_lshlrev_b32 v22, 16, v81
  v_and_b32 v23, s36, v81
  v_lshlrev_b32 v24, 16, v82
  v_and_b32 v25, s36, v82
  v_lshlrev_b32 v26, 16, v83
  v_and_b32 v27, s36, v83
  v_lshlrev_b32 v48, 16, v92
  v_and_b32 v49, s36, v92
  v_pk_mul_f32 v[50:51], v[20:21], v[18:19]
  v_pk_fma_f32 v[50:51], v[22:23], v[16:17], v[50:51]
  v_pk_fma_f32 v[50:51], v[24:25], v[14:15], v[50:51]
  v_pk_fma_f32 v[50:51], v[26:27], v[12:13], v[50:51]
  v_pk_mul_f32 v[50:51], v[50:51], v[48:49]
  v_lshlrev_b32 v20, 16, v84
  v_and_b32 v21, s36, v84
  v_lshlrev_b32 v48, 16, v93
  v_and_b32 v49, s36, v93
  v_pk_mul_f32 v[52:53], v[22:23], v[18:19]
  v_pk_fma_f32 v[52:53], v[24:25], v[16:17], v[52:53]
  v_pk_fma_f32 v[52:53], v[26:27], v[14:15], v[52:53]
  v_pk_fma_f32 v[52:53], v[20:21], v[12:13], v[52:53]
  v_pk_mul_f32 v[52:53], v[52:53], v[48:49]
  v_cvt_pk_bf16_f32 v103, v52, v50
  v_cvt_pk_bf16_f32 v107, v53, v51
  v_lshlrev_b32 v22, 16, v85
  v_and_b32 v23, s36, v85
  v_lshlrev_b32 v48, 16, v94
  v_and_b32 v49, s36, v94
  v_pk_mul_f32 v[50:51], v[24:25], v[18:19]
  v_pk_fma_f32 v[50:51], v[26:27], v[16:17], v[50:51]
  v_pk_fma_f32 v[50:51], v[20:21], v[14:15], v[50:51]
  v_pk_fma_f32 v[50:51], v[22:23], v[12:13], v[50:51]
  v_pk_mul_f32 v[50:51], v[50:51], v[48:49]
  v_lshlrev_b32 v24, 16, v86
  v_and_b32 v25, s36, v86
  v_lshlrev_b32 v48, 16, v95
  v_and_b32 v49, s36, v95
  v_pk_mul_f32 v[52:53], v[26:27], v[18:19]
  v_pk_fma_f32 v[52:53], v[20:21], v[16:17], v[52:53]
  v_pk_fma_f32 v[52:53], v[22:23], v[14:15], v[52:53]
  v_pk_fma_f32 v[52:53], v[24:25], v[12:13], v[52:53]
  v_pk_mul_f32 v[52:53], v[52:53], v[48:49]
  v_cvt_pk_bf16_f32 v102, v52, v50
  v_cvt_pk_bf16_f32 v106, v53, v51
  v_lshlrev_b32 v26, 16, v87
  v_and_b32 v27, s36, v87
  v_lshlrev_b32 v48, 16, v96
  v_and_b32 v49, s36, v96
  v_pk_mul_f32 v[50:51], v[20:21], v[18:19]
  v_pk_fma_f32 v[50:51], v[22:23], v[16:17], v[50:51]
  v_pk_fma_f32 v[50:51], v[24:25], v[14:15], v[50:51]
  v_pk_fma_f32 v[50:51], v[26:27], v[12:13], v[50:51]
  v_pk_mul_f32 v[50:51], v[50:51], v[48:49]
  v_lshlrev_b32 v20, 16, v88
  v_and_b32 v21, s36, v88
  v_lshlrev_b32 v48, 16, v97
  v_and_b32 v49, s36, v97
  v_pk_mul_f32 v[52:53], v[22:23], v[18:19]
  v_pk_fma_f32 v[52:53], v[24:25], v[16:17], v[52:53]
  v_pk_fma_f32 v[52:53], v[26:27], v[14:15], v[52:53]
  v_pk_fma_f32 v[52:53], v[20:21], v[12:13], v[52:53]
  v_pk_mul_f32 v[52:53], v[52:53], v[48:49]
  v_cvt_pk_bf16_f32 v101, v52, v50
  v_cvt_pk_bf16_f32 v105, v53, v51
  v_lshlrev_b32 v22, 16, v89
  v_and_b32 v23, s36, v89
  v_lshlrev_b32 v48, 16, v98
  v_and_b32 v49, s36, v98
  v_pk_mul_f32 v[50:51], v[24:25], v[18:19]
  v_pk_fma_f32 v[50:51], v[26:27], v[16:17], v[50:51]
  v_pk_fma_f32 v[50:51], v[20:21], v[14:15], v[50:51]
  v_pk_fma_f32 v[50:51], v[22:23], v[12:13], v[50:51]
  v_pk_mul_f32 v[50:51], v[50:51], v[48:49]
  v_lshlrev_b32 v24, 16, v90
  v_and_b32 v25, s36, v90
  v_lshlrev_b32 v48, 16, v99
  v_and_b32 v49, s36, v99
  v_pk_mul_f32 v[52:53], v[26:27], v[18:19]
  v_pk_fma_f32 v[52:53], v[20:21], v[16:17], v[52:53]
  v_pk_fma_f32 v[52:53], v[22:23], v[14:15], v[52:53]
  v_pk_fma_f32 v[52:53], v[24:25], v[12:13], v[52:53]
  v_pk_mul_f32 v[52:53], v[52:53], v[48:49]
  v_cvt_pk_bf16_f32 v100, v52, v50
  v_cvt_pk_bf16_f32 v104, v53, v51
L_PN2:
LW_15:
  ds_read_b32 v127, v125 offset:100
  s_waitcnt lgkmcnt(0)
  v_readfirstlane_b32 s60, v127
  s_cmp_ge_u32 s60, 4
  s_cbranch_scc1 LW_15_d
  s_sleep 1
  s_branch LW_15
LW_15_d:
  ds_read_b128 v[56:59], v65
  ds_read_b128 v[60:63], v65 offset:1152
  s_waitcnt lgkmcnt(0)
  s_cmp_lt_u32 s19, 28
  s_cbranch_scc1 L_PREPD
  s_mov_b64 exec, 1
  ds_add_u32 v125, v126 offset:104
  s_mov_b64 exec, -1
LW_16:
  ds_read_b32 v127, v125 offset:104
  s_waitcnt lgkmcnt(0)
  v_readfirstlane_b32 s60, v127
  s_cmp_ge_u32 s60, 4
  s_cbranch_scc1 LW_16_d
  s_sleep 1
  s_branch LW_16
LW_16_d:
  ds_write_b128 v64, v[100:103]
  ds_write_b128 v64, v[104:107] offset:144
  s_mov_b64 exec, 1
  ds_add_u32 v125, v126 offset:100
  s_mov_b64 exec, -1
LW_17:
  ds_read_b32 v127, v125 offset:100
  s_waitcnt lgkmcnt(0)
  v_readfirstlane_b32 s60, v127
  s_cmp_ge_u32 s60, 8
  s_cbranch_scc1 LW_17_d
  s_sleep 1
  s_branch LW_17
LW_17_d:
  ds_read_b128 v[100:103], v65
  ds_read_b128 v[104:107], v65 offset:1152
  s_waitcnt lgkmcnt(0)
L_PREPD:
LW_18:
  ds_read_b32 v127, v125 offset:52
  s_waitcnt lgkmcnt(0)
  v_readfirstlane_b32 s61, v127
  s_cmp_ge_u32 s61, 1
  s_cbranch_scc1 LW_18_d
  s_sleep 1
  s_branch LW_18
LW_18_d:
LW_19:
  ds_read_b32 v127, v125 offset:56
  s_waitcnt lgkmcnt(0)
  v_readfirstlane_b32 s60, v127
  s_cmp_ge_u32 s60, 4
  s_cbranch_scc1 LW_19_d
  s_sleep 1
  s_branch LW_19
LW_19_d:
  s_mov_b32 s37, 32768
  buffer_store_dwordx4 v[56:59], v66, s[52:55], 0 offen sc1
  buffer_store_dwordx4 v[60:63], v66, s[52:55], s37 offen sc1
  s_cmp_lt_u32 s19, 28
  s_cbranch_scc1 L_PN4
  s_mov_b32 s37, 32768
  buffer_store_dwordx4 v[100:103], v66, s[40:43], 0 offen sc1
  buffer_store_dwordx4 v[104:107], v66, s[40:43], s37 offen sc1
L_PN4:
  s_mov_b64 exec, 1
  buffer_store_dword v70, v71, s[48:51], s57 offen sc1
  s_mov_b64 exec, -1
  v_mov_b32 v127, s61
  v_lshlrev_b32 v124, 4, v2
  s_mov_b64 exec, 1
  s_waitcnt vmcnt(0)
  buffer_store_dword v127, v124, s[44:47], s38 offen sc1
  s_mov_b64 exec, -1
  s_cmp_lt_u32 s19, 28
  s_cbranch_scc1 L_PN3
  s_mov_b64 exec, 1
  buffer_store_dword v127, v124, s[44:47], s39 offen sc1
  s_mov_b64 exec, -1
L_PN3:
  s_mov_b64 exec, 1
  ds_add_u32 v125, v126 offset:64
  s_mov_b64 exec, -1
  s_lshl_b32 s21, s18, 5
  s_add_u32 s21, s21, s19
  s_cmp_ge_u32 s21, 108
  s_cbranch_scc1 L_CONVNONE
  s_sub_u32 s22, s21, 72
  s_lshl_b32 s22, s22, 1
  s_cmp_ge_u32 s21, 72
  s_cselect_b32 s21, s22, s21
  s_cselect_b32 s57, 1, 0
  s_mul_i32 s22, s3, 72
  s_add_u32 s21, s21, s22
  s_lshr_b32 s22, s21, 6
  s_and_b32 s23, s21, 63
  v_lshrrev_b32 v4, 3, v1
  v_lshlrev_b32 v4, 9, v4
  v_and_b32 v5, 7, v1
  v_lshl_add_u32 v4, v5, 1, v4
  v_lshl_add_u32 v4, v3, 4, v4
  s_lshl_b32 s36, s57, 11
  s_add_u32 s36, s36, 18
  v_add_u32 v4, s36, v4
  v_subrev_u32 v5, 32, v4
  v_sub_u32 v6, 31, v1
  v_add_u32 v6, v6, v3
  v_lshlrev_b32 v6, 4, v6
  v_lshlrev_b32 v7, 4, v2
  s_mul_i32 s43, s18, 4608
  v_add_u32 v6, s43, v6
  s_lshl_b32 s36, s21, 12
  s_add_u32 s38, s36, 3145728
  s_lshl_b32 s39, s22, 11
  s_add_u32 s39, s39, 311296
  s_add_u32 s44, s14, s36
  s_addc_u32 s45, s15, 0
  s_mov_b32 s46, 4096
  s_mov_b32 s47, 0x20000
  s_add_u32 s32, s4, s38
  s_addc_u32 s33, s5, 0
  s_mov_b32 s34, 8192
  s_mov_b32 s35, 0x20000
  s_add_u32 s24, s4, s39
  s_addc_u32 s25, s5, 0
  s_mov_b32 s26, 2048
  s_mov_b32 s27, 0x20000
  s_add_u32 s52, s4, 335872
  s_addc_u32 s53, s5, 0
  s_mov_b32 s54, 32768
  s_mov_b32 s55, 0x20000
  s_mov_b32 s48, s12
  s_mov_b32 s49, s13
  s_mov_b32 s50, 1152
  s_mov_b32 s51, 0x20000
  s_mul_i32 s36, s21, 6144
  s_add_u32 s36, s36, 6553600
  s_add_u32 s28, s4, s36
  s_addc_u32 s29, s5, 0
  s_mov_b32 s30, 12288
  s_mov_b32 s31, 0x20000
LW_20:
  ds_read_b32 v127, v125 offset:64
  s_waitcnt lgkmcnt(0)
  v_readfirstlane_b32 s60, v127
  s_cmp_ge_u32 s60, 4
  s_cbranch_scc1 LW_20_d
  s_sleep 2
  s_branch LW_20
LW_20_d:
  s_cmp_ge_u32 s17, 6
  s_cselect_b32 s36, 3, 2
LW_21:
  ds_read_b32 v127, v125 offset:124
  s_waitcnt lgkmcnt(0)
  v_readfirstlane_b32 s60, v127
  s_cmp_ge_u32 s60, s36
  s_cbranch_scc1 LW_21_d
  s_sleep 4
  s_branch LW_21
LW_21_d:
  s_cmp_eq_u32 s57, 1
  s_cbranch_scc1 L_CONVQ
  v_and_b32 v112, -4, v4
  v_and_b32 v113, -4, v5
  v_and_b32 v114, 2, v4
  v_lshlrev_b32 v114, 3, v114
  buffer_load_dwordx4 v[12:15], v112, s[44:47], 0 offen offset:0
  buffer_load_dword v101, v112, s[44:47], 0 offen offset:16
  buffer_load_dwordx4 v[16:19], v112, s[44:47], 0 offen offset:32
  buffer_load_dword v102, v112, s[44:47], 0 offen offset:48
  buffer_load_dwordx4 v[20:23], v112, s[44:47], 0 offen offset:64
  buffer_load_dword v103, v112, s[44:47], 0 offen offset:80
  buffer_load_dwordx4 v[24:27], v112, s[44:47], 0 offen offset:96
  buffer_load_dword v104, v112, s[44:47], 0 offen offset:112
  buffer_load_dwordx4 v[28:31], v112, s[44:47], 0 offen offset:128
  buffer_load_dword v105, v112, s[44:47], 0 offen offset:144
  buffer_load_dwordx4 v[32:35], v112, s[44:47], 0 offen offset:160
  buffer_load_dword v106, v112, s[44:47], 0 offen offset:176
  buffer_load_dwordx4 v[36:39], v112, s[44:47], 0 offen offset:192
  buffer_load_dword v107, v112, s[44:47], 0 offen offset:208
  buffer_load_dwordx4 v[40:43], v112, s[44:47], 0 offen offset:224
  buffer_load_dword v108, v112, s[44:47], 0 offen offset:240
  buffer_load_dwordx4 v[44:47], v112, s[44:47], 0 offen offset:256
  buffer_load_dword v109, v112, s[44:47], 0 offen offset:272
  buffer_load_dwordx4 v[48:51], v112, s[44:47], 0 offen offset:288
  buffer_load_dword v110, v112, s[44:47], 0 offen offset:304
  buffer_load_dwordx4 v[52:55], v112, s[44:47], 0 offen offset:320
  buffer_load_dword v111, v112, s[44:47], 0 offen offset:336
  buffer_load_dwordx4 v[56:59], v112, s[44:47], 0 offen offset:352
  buffer_load_dword v120, v112, s[44:47], 0 offen offset:368
  buffer_load_dwordx4 v[60:63], v112, s[44:47], 0 offen offset:384
  buffer_load_dword v121, v112, s[44:47], 0 offen offset:400
  buffer_load_dwordx4 v[64:67], v112, s[44:47], 0 offen offset:416
  buffer_load_dword v122, v112, s[44:47], 0 offen offset:432
  buffer_load_dwordx4 v[68:71], v112, s[44:47], 0 offen offset:448
  buffer_load_dword v123, v112, s[44:47], 0 offen offset:464
  v_add_u32 v72, 0, v5
  buffer_load_ushort v80, v72, s[44:47], 0 offen
  v_add_u32 v73, 2, v5
  buffer_load_ushort v81, v73, s[44:47], 0 offen
  v_add_u32 v74, 4, v5
  buffer_load_ushort v82, v74, s[44:47], 0 offen
  v_add_u32 v75, 6, v5
  buffer_load_ushort v83, v75, s[44:47], 0 offen
  v_add_u32 v76, 8, v5
  buffer_load_ushort v84, v76, s[44:47], 0 offen
  v_add_u32 v77, 10, v5
  buffer_load_ushort v85, v77, s[44:47], 0 offen
  v_add_u32 v78, 12, v5
  buffer_load_ushort v86, v78, s[44:47], 0 offen
  v_add_u32 v79, 14, v5
  buffer_load_ushort v87, v79, s[44:47], 0 offen
  s_lshl_b32 s36, s21, 1
  v_mov_b32 v88, 0
  buffer_load_ushort v89, v88, s[48:51], s36 offen
  buffer_load_ushort v90, v88, s[44:47], 0 offen
  s_waitcnt vmcnt(0)
  s_setprio 3
  v_lshlrev_b32 v89, 16, v89
  v_lshlrev_b32 v90, 16, v90
  v_add_f32 v89, v89, v90
  v_cvt_pk_bf16_f32 v89, v89, 0
  v_cmp_eq_u32 vcc, 0, v72
  s_nop 1
  v_cndmask_b32 v80, v80, v89, vcc
  v_cmp_eq_u32 vcc, 0, v73
  s_nop 1
  v_cndmask_b32 v81, v81, v89, vcc
  v_cmp_eq_u32 vcc, 0, v74
  s_nop 1
  v_cndmask_b32 v82, v82, v89, vcc
  v_cmp_eq_u32 vcc, 0, v75
  s_nop 1
  v_cndmask_b32 v83, v83, v89, vcc
  v_cmp_eq_u32 vcc, 0, v76
  s_nop 1
  v_cndmask_b32 v84, v84, v89, vcc
  v_cmp_eq_u32 vcc, 0, v77
  s_nop 1
  v_cndmask_b32 v85, v85, v89, vcc
  v_cmp_eq_u32 vcc, 0, v78
  s_nop 1
  v_cndmask_b32 v86, v86, v89, vcc
  v_cmp_eq_u32 vcc, 0, v79
  s_nop 1
  v_cndmask_b32 v87, v87, v89, vcc
  v_lshl_or_b32 v8, v81, 16, v80
  v_lshl_or_b32 v9, v83, 16, v82
  v_lshl_or_b32 v10, v85, 16, v84
  v_lshl_or_b32 v11, v87, 16, v86
  v_alignbit_b32 v12, v13, v12, v114
  v_alignbit_b32 v13, v14, v13, v114
  v_alignbit_b32 v14, v15, v14, v114
  v_alignbit_b32 v15, v101, v15, v114
  v_alignbit_b32 v16, v17, v16, v114
  v_alignbit_b32 v17, v18, v17, v114
  v_alignbit_b32 v18, v19, v18, v114
  v_alignbit_b32 v19, v102, v19, v114
  v_alignbit_b32 v20, v21, v20, v114
  v_alignbit_b32 v21, v22, v21, v114
  v_alignbit_b32 v22, v23, v22, v114
  v_alignbit_b32 v23, v103, v23, v114
  v_alignbit_b32 v24, v25, v24, v114
  v_alignbit_b32 v25, v26, v25, v114
  v_alignbit_b32 v26, v27, v26, v114
  v_alignbit_b32 v27, v104, v27, v114
  v_alignbit_b32 v28, v29, v28, v114
  v_alignbit_b32 v29, v30, v29, v114
  v_alignbit_b32 v30, v31, v30, v114
  v_alignbit_b32 v31, v105, v31, v114
  v_alignbit_b32 v32, v33, v32, v114
  v_alignbit_b32 v33, v34, v33, v114
  v_alignbit_b32 v34, v35, v34, v114
  v_alignbit_b32 v35, v106, v35, v114
  v_alignbit_b32 v36, v37, v36, v114
  v_alignbit_b32 v37, v38, v37, v114
  v_alignbit_b32 v38, v39, v38, v114
  v_alignbit_b32 v39, v107, v39, v114
  v_alignbit_b32 v40, v41, v40, v114
  v_alignbit_b32 v41, v42, v41, v114
  v_alignbit_b32 v42, v43, v42, v114
  v_alignbit_b32 v43, v108, v43, v114
  v_alignbit_b32 v44, v45, v44, v114
  v_alignbit_b32 v45, v46, v45, v114
  v_alignbit_b32 v46, v47, v46, v114
  v_alignbit_b32 v47, v109, v47, v114
  v_alignbit_b32 v48, v49, v48, v114
  v_alignbit_b32 v49, v50, v49, v114
  v_alignbit_b32 v50, v51, v50, v114
  v_alignbit_b32 v51, v110, v51, v114
  v_alignbit_b32 v52, v53, v52, v114
  v_alignbit_b32 v53, v54, v53, v114
  v_alignbit_b32 v54, v55, v54, v114
  v_alignbit_b32 v55, v111, v55, v114
  v_alignbit_b32 v56, v57, v56, v114
  v_alignbit_b32 v57, v58, v57, v114
  v_alignbit_b32 v58, v59, v58, v114
  v_alignbit_b32 v59, v120, v59, v114
  v_alignbit_b32 v60, v61, v60, v114
  v_alignbit_b32 v61, v62, v61, v114
  v_alignbit_b32 v62, v63, v62, v114
  v_alignbit_b32 v63, v121, v63, v114
  v_alignbit_b32 v64, v65, v64, v114
  v_alignbit_b32 v65, v66, v65, v114
  v_alignbit_b32 v66, v67, v66, v114
  v_alignbit_b32 v67, v122, v67, v114
  v_alignbit_b32 v68, v69, v68, v114
  v_alignbit_b32 v69, v70, v69, v114
  v_alignbit_b32 v70, v71, v70, v114
  v_alignbit_b32 v71, v123, v71, v114
  v_mov_b32 v72, 0
  v_mov_b32 v73, 0
  v_mov_b32 v74, 0
  v_mov_b32 v75, 0
  v_mov_b32 v76, 0
  v_mov_b32 v77, 0
  v_mov_b32 v78, 0
  v_mov_b32 v79, 0
  v_mov_b32 v80, 0
  v_mov_b32 v81, 0
  v_mov_b32 v82, 0
  v_mov_b32 v83, 0
  v_mov_b32 v84, 0
  v_mov_b32 v85, 0
  v_mov_b32 v86, 0
  v_mov_b32 v87, 0
  v_mov_b32 v88, 0
  v_mov_b32 v89, 0
  v_mov_b32 v90, 0
  v_mov_b32 v91, 0
  v_mov_b32 v92, 0
  v_mov_b32 v93, 0
  v_mov_b32 v94, 0
  v_mov_b32 v95, 0
  v_mov_b32 v96, 0
  v_mov_b32 v97, 0
  v_mov_b32 v98, 0
  v_mov_b32 v99, 0
  v_mov_b32 v100, 0
  v_mov_b32 v101, 0
  v_mov_b32 v102, 0
  v_mov_b32 v103, 0
  s_setprio 3
  s_lshl_b32 s37, s2, 7
  s_lshl_b32 s38, s22, 2
  s_add_u32 s37, s37, s38
LW_22:
  ds_read_b32 v127, v125 offset:108
  s_waitcnt lgkmcnt(0)
  v_readfirstlane_b32 s60, v127
  s_cmp_ge_u32 s60, 8
  s_cbranch_scc1 LW_22_d
  s_sleep 8
  s_branch LW_22
LW_22_d:
  s_mov_b32 exec_lo, 1
  s_mov_b32 exec_hi, 0
  s_mov_b32 s62, 0
GP_23:
  buffer_load_dword v127, v7, s[52:55], s37 offen offset:0 sc1
  s_add_u32 s62, s62, 1
  s_waitcnt vmcnt(0)
  v_cmp_ne_u32 vcc, s61, v127
  s_cmp_eq_u64 vcc, 0
  s_cbranch_scc1 GP_23_d
  s_mov_b64 exec, vcc
  s_cmp_ge_u32 s62, 32768
  s_cbranch_scc1 GP_23_d
  s_sleep 6
  s_branch GP_23
GP_23_d:
  s_mov_b64 exec, -1
  s_mov_b32 m0, s43
  s_movk_i32 s37, 6144
  s_mov_b32 s38, 0x100000
  buffer_load_dwordx4 v7, s[32:35], 0 offen offset:0 sc1 lds
  buffer_load_dwordx4 v7, s[32:35], 0 offen offset:1024 sc1 lds
  buffer_load_dwordx4 v7, s[32:35], 0 offen offset:2048 sc1 lds
  buffer_load_dwordx4 v7, s[32:35], 0 offen offset:3072 sc1 lds
  s_add_u32 m0, s43, 4096
  s_mov_b32 exec_hi, 0
  buffer_load_dwordx4 v7, s[32:35], s38 offen lds
  s_mov_b32 exec_hi, -1
  s_waitcnt vmcnt(0)
  s_setprio 0
  ds_read_b128 v[116:119], v6 offset:0
  ds_read_b128 v[120:123], v6 offset:32
  s_waitcnt lgkmcnt(1)
  v_mfma_f32_32x32x16_bf16 v[100:115], v[8:11], v[116:119], v[100:115]
  ds_read_b128 v[116:119], v6 offset:64
  s_waitcnt lgkmcnt(1)
  v_mfma_f32_32x32x16_bf16 v[100:115], v[12:15], v[120:123], v[100:115]
  ds_read_b128 v[120:123], v6 offset:96
  s_waitcnt lgkmcnt(1)
  v_mfma_f32_32x32x16_bf16 v[100:115], v[16:19], v[116:119], v[100:115]
  ds_read_b128 v[116:119], v6 offset:128
  s_waitcnt lgkmcnt(1)
  v_mfma_f32_32x32x16_bf16 v[100:115], v[20:23], v[120:123], v[100:115]
  ds_read_b128 v[120:123], v6 offset:160
  s_waitcnt lgkmcnt(1)
  ds_read_b32 v124, v125 offset:84
  v_mfma_f32_32x32x16_bf16 v[100:115], v[24:27], v[116:119], v[100:115]
  ds_read_b128 v[116:119], v6 offset:192
  s_waitcnt lgkmcnt(1)
  v_mfma_f32_32x32x16_bf16 v[100:115], v[28:31], v[120:123], v[100:115]
  ds_read_b128 v[120:123], v6 offset:224
  s_waitcnt lgkmcnt(1)
  v_mfma_f32_32x32x16_bf16 v[100:115], v[32:35], v[116:119], v[100:115]
  ds_read_b128 v[116:119], v6 offset:256
  s_waitcnt lgkmcnt(1)
  v_mfma_f32_32x32x16_bf16 v[100:115], v[36:39], v[120:123], v[100:115]
  ds_read_b128 v[120:123], v6 offset:288
  s_waitcnt lgkmcnt(1)
  v_readfirstlane_b32 s60, v124
  s_cmp_lt_u32 s60, 4
  s_cbranch_scc1 CA_24
  s_setprio 3
CA_24:
  v_mfma_f32_32x32x16_bf16 v[100:115], v[40:43], v[116:119], v[100:115]
  ds_read_b128 v[116:119], v6 offset:320
  s_waitcnt lgkmcnt(1)
  v_mfma_f32_32x32x16_bf16 v[100:115], v[44:47], v[120:123], v[100:115]
  ds_read_b128 v[120:123], v6 offset:352
  s_waitcnt lgkmcnt(1)
  v_mfma_f32_32x32x16_bf16 v[100:115], v[48:51], v[116:119], v[100:115]
  ds_read_b128 v[116:119], v6 offset:384
  s_waitcnt lgkmcnt(1)
  v_mfma_f32_32x32x16_bf16 v[100:115], v[52:55], v[120:123], v[100:115]
  ds_read_b128 v[120:123], v6 offset:416
  s_waitcnt lgkmcnt(1)
  ds_read_b32 v124, v125 offset:84
  v_mfma_f32_32x32x16_bf16 v[100:115], v[56:59], v[116:119], v[100:115]
  ds_read_b128 v[116:119], v6 offset:448
  s_waitcnt lgkmcnt(1)
  v_mfma_f32_32x32x16_bf16 v[100:115], v[60:63], v[120:123], v[100:115]
  ds_read_b128 v[120:123], v6 offset:480
  s_waitcnt lgkmcnt(1)
  v_mfma_f32_32x32x16_bf16 v[100:115], v[64:67], v[116:119], v[100:115]
  ds_read_b128 v[116:119], v6 offset:512
  s_waitcnt lgkmcnt(1)
  v_mfma_f32_32x32x16_bf16 v[100:115], v[68:71], v[120:123], v[100:115]
  ds_read_b128 v[120:123], v6 offset:544
  s_waitcnt lgkmcnt(1)
  s_nop 4
  v_readfirstlane_b32 s60, v124
  s_cmp_lt_u32 s60, 4
  s_cbranch_scc1 CA_25
  s_setprio 3
CA_25:
  v_mfma_f32_32x32x16_bf16 v[96:111], v[8:11], v[116:119], v[96:111]
  ds_read_b128 v[116:119], v6 offset:576
  s_waitcnt lgkmcnt(1)
  v_mfma_f32_32x32x16_bf16 v[96:111], v[12:15], v[120:123], v[96:111]
  ds_read_b128 v[120:123], v6 offset:608
  s_waitcnt lgkmcnt(1)
  v_mfma_f32_32x32x16_bf16 v[96:111], v[16:19], v[116:119], v[96:111]
  ds_read_b128 v[116:119], v6 offset:640
  s_waitcnt lgkmcnt(1)
  v_mfma_f32_32x32x16_bf16 v[96:111], v[20:23], v[120:123], v[96:111]
  ds_read_b128 v[120:123], v6 offset:672
  s_waitcnt lgkmcnt(1)
  ds_read_b32 v124, v125 offset:84
  v_mfma_f32_32x32x16_bf16 v[96:111], v[24:27], v[116:119], v[96:111]
  ds_read_b128 v[116:119], v6 offset:704
  s_waitcnt lgkmcnt(1)
  v_mfma_f32_32x32x16_bf16 v[96:111], v[28:31], v[120:123], v[96:111]
  ds_read_b128 v[120:123], v6 offset:736
  s_waitcnt lgkmcnt(1)
  v_mfma_f32_32x32x16_bf16 v[96:111], v[32:35], v[116:119], v[96:111]
  ds_read_b128 v[116:119], v6 offset:768
  s_waitcnt lgkmcnt(1)
  v_mfma_f32_32x32x16_bf16 v[96:111], v[36:39], v[120:123], v[96:111]
  ds_read_b128 v[120:123], v6 offset:800
  s_waitcnt lgkmcnt(1)
  v_readfirstlane_b32 s60, v124
  s_cmp_lt_u32 s60, 4
  s_cbranch_scc1 CA_26
  s_setprio 3
CA_26:
  v_mfma_f32_32x32x16_bf16 v[96:111], v[40:43], v[116:119], v[96:111]
  ds_read_b128 v[116:119], v6 offset:832
  s_waitcnt lgkmcnt(1)
  v_mfma_f32_32x32x16_bf16 v[96:111], v[44:47], v[120:123], v[96:111]
  ds_read_b128 v[120:123], v6 offset:864
  s_waitcnt lgkmcnt(1)
  v_mfma_f32_32x32x16_bf16 v[96:111], v[48:51], v[116:119], v[96:111]
  ds_read_b128 v[116:119], v6 offset:896
  s_waitcnt lgkmcnt(1)
  v_mfma_f32_32x32x16_bf16 v[96:111], v[52:55], v[120:123], v[96:111]
  ds_read_b128 v[120:123], v6 offset:928
  s_waitcnt lgkmcnt(1)
  ds_read_b32 v124, v125 offset:84
  v_mfma_f32_32x32x16_bf16 v[96:111], v[56:59], v[116:119], v[96:111]
  ds_read_b128 v[116:119], v6 offset:960
  s_waitcnt lgkmcnt(1)
  v_mfma_f32_32x32x16_bf16 v[96:111], v[60:63], v[120:123], v[96:111]
  ds_read_b128 v[120:123], v6 offset:992
  s_waitcnt lgkmcnt(1)
  v_mfma_f32_32x32x16_bf16 v[96:111], v[64:67], v[116:119], v[96:111]
  ds_read_b128 v[116:119], v6 offset:1024
  s_waitcnt lgkmcnt(1)
  v_mfma_f32_32x32x16_bf16 v[96:111], v[68:71], v[120:123], v[96:111]
  ds_read_b128 v[120:123], v6 offset:1056
  s_waitcnt lgkmcnt(1)
  s_nop 4
  v_readfirstlane_b32 s60, v124
  s_cmp_lt_u32 s60, 4
  s_cbranch_scc1 CA_27
  s_setprio 3
CA_27:
  v_mfma_f32_32x32x16_bf16 v[92:107], v[8:11], v[116:119], v[92:107]
  ds_read_b128 v[116:119], v6 offset:1088
  s_waitcnt lgkmcnt(1)
  v_mfma_f32_32x32x16_bf16 v[92:107], v[12:15], v[120:123], v[92:107]
  ds_read_b128 v[120:123], v6 offset:1120
  s_waitcnt lgkmcnt(1)
  v_mfma_f32_32x32x16_bf16 v[92:107], v[16:19], v[116:119], v[92:107]
  ds_read_b128 v[116:119], v6 offset:1152
  s_waitcnt lgkmcnt(1)
  v_mfma_f32_32x32x16_bf16 v[92:107], v[20:23], v[120:123], v[92:107]
  ds_read_b128 v[120:123], v6 offset:1184
  s_waitcnt lgkmcnt(1)
  ds_read_b32 v124, v125 offset:84
  v_mfma_f32_32x32x16_bf16 v[92:107], v[24:27], v[116:119], v[92:107]
  ds_read_b128 v[116:119], v6 offset:1216
  s_waitcnt lgkmcnt(1)
  v_mfma_f32_32x32x16_bf16 v[92:107], v[28:31], v[120:123], v[92:107]
  ds_read_b128 v[120:123], v6 offset:1248
  s_waitcnt lgkmcnt(1)
  v_mfma_f32_32x32x16_bf16 v[92:107], v[32:35], v[116:119], v[92:107]
  ds_read_b128 v[116:119], v6 offset:1280
  s_waitcnt lgkmcnt(1)
  v_mfma_f32_32x32x16_bf16 v[92:107], v[36:39], v[120:123], v[92:107]
  ds_read_b128 v[120:123], v6 offset:1312
  s_waitcnt lgkmcnt(1)
  v_readfirstlane_b32 s60, v124
  s_cmp_lt_u32 s60, 4
  s_cbranch_scc1 CA_28
  s_setprio 3
CA_28:
  v_mfma_f32_32x32x16_bf16 v[92:107], v[40:43], v[116:119], v[92:107]
  ds_read_b128 v[116:119], v6 offset:1344
  s_waitcnt lgkmcnt(1)
  v_mfma_f32_32x32x16_bf16 v[92:107], v[44:47], v[120:123], v[92:107]
  ds_read_b128 v[120:123], v6 offset:1376
  s_waitcnt lgkmcnt(1)
  v_mfma_f32_32x32x16_bf16 v[92:107], v[48:51], v[116:119], v[92:107]
  ds_read_b128 v[116:119], v6 offset:1408
  s_waitcnt lgkmcnt(1)
  v_mfma_f32_32x32x16_bf16 v[92:107], v[52:55], v[120:123], v[92:107]
  ds_read_b128 v[120:123], v6 offset:1440
  s_waitcnt lgkmcnt(1)
  ds_read_b32 v124, v125 offset:84
  v_mfma_f32_32x32x16_bf16 v[92:107], v[56:59], v[116:119], v[92:107]
  ds_read_b128 v[116:119], v6 offset:1472
  s_waitcnt lgkmcnt(1)
  v_mfma_f32_32x32x16_bf16 v[92:107], v[60:63], v[120:123], v[92:107]
  ds_read_b128 v[120:123], v6 offset:1504
  s_waitcnt lgkmcnt(1)
  v_mfma_f32_32x32x16_bf16 v[92:107], v[64:67], v[116:119], v[92:107]
  ds_read_b128 v[116:119], v6 offset:1536
  s_waitcnt lgkmcnt(1)
  v_mfma_f32_32x32x16_bf16 v[92:107], v[68:71], v[120:123], v[92:107]
  ds_read_b128 v[120:123], v6 offset:1568
  s_waitcnt lgkmcnt(1)
  s_nop 4
  v_readfirstlane_b32 s60, v124
  s_cmp_lt_u32 s60, 4
  s_cbranch_scc1 CA_29
  s_setprio 3
CA_29:
  v_mfma_f32_32x32x16_bf16 v[88:103], v[8:11], v[116:119], v[88:103]
  ds_read_b128 v[116:119], v6 offset:1600
  s_waitcnt lgkmcnt(1)
  v_mfma_f32_32x32x16_bf16 v[88:103], v[12:15], v[120:123], v[88:103]
  ds_read_b128 v[120:123], v6 offset:1632
  s_waitcnt lgkmcnt(1)
  v_mfma_f32_32x32x16_bf16 v[88:103], v[16:19], v[116:119], v[88:103]
  ds_read_b128 v[116:119], v6 offset:1664
  s_waitcnt lgkmcnt(1)
  v_mfma_f32_32x32x16_bf16 v[88:103], v[20:23], v[120:123], v[88:103]
  ds_read_b128 v[120:123], v6 offset:1696
  s_waitcnt lgkmcnt(1)
  ds_read_b32 v124, v125 offset:84
  v_mfma_f32_32x32x16_bf16 v[88:103], v[24:27], v[116:119], v[88:103]
  ds_read_b128 v[116:119], v6 offset:1728
  s_waitcnt lgkmcnt(1)
  v_mfma_f32_32x32x16_bf16 v[88:103], v[28:31], v[120:123], v[88:103]
  ds_read_b128 v[120:123], v6 offset:1760
  s_waitcnt lgkmcnt(1)
  v_mfma_f32_32x32x16_bf16 v[88:103], v[32:35], v[116:119], v[88:103]
  ds_read_b128 v[116:119], v6 offset:1792
  s_waitcnt lgkmcnt(1)
  v_mfma_f32_32x32x16_bf16 v[88:103], v[36:39], v[120:123], v[88:103]
  ds_read_b128 v[120:123], v6 offset:1824
  s_waitcnt lgkmcnt(1)
  v_readfirstlane_b32 s60, v124
  s_cmp_lt_u32 s60, 4
  s_cbranch_scc1 CA_30
  s_setprio 3
CA_30:
  v_mfma_f32_32x32x16_bf16 v[88:103], v[40:43], v[116:119], v[88:103]
  ds_read_b128 v[116:119], v6 offset:1856
  s_waitcnt lgkmcnt(1)
  v_mfma_f32_32x32x16_bf16 v[88:103], v[44:47], v[120:123], v[88:103]
  ds_read_b128 v[120:123], v6 offset:1888
  s_waitcnt lgkmcnt(1)
  v_mfma_f32_32x32x16_bf16 v[88:103], v[48:51], v[116:119], v[88:103]
  ds_read_b128 v[116:119], v6 offset:1920
  s_waitcnt lgkmcnt(1)
  v_mfma_f32_32x32x16_bf16 v[88:103], v[52:55], v[120:123], v[88:103]
  ds_read_b128 v[120:123], v6 offset:1952
  s_waitcnt lgkmcnt(1)
  ds_read_b32 v124, v125 offset:84
  v_mfma_f32_32x32x16_bf16 v[88:103], v[56:59], v[116:119], v[88:103]
  ds_read_b128 v[116:119], v6 offset:1984
  s_waitcnt lgkmcnt(1)
  v_mfma_f32_32x32x16_bf16 v[88:103], v[60:63], v[120:123], v[88:103]
  ds_read_b128 v[120:123], v6 offset:2016
  s_waitcnt lgkmcnt(1)
  v_mfma_f32_32x32x16_bf16 v[88:103], v[64:67], v[116:119], v[88:103]
  ds_read_b128 v[116:119], v6 offset:2048
  s_waitcnt lgkmcnt(1)
  v_mfma_f32_32x32x16_bf16 v[88:103], v[68:71], v[120:123], v[88:103]
  ds_read_b128 v[120:123], v6 offset:2080
  s_waitcnt lgkmcnt(1)
  s_nop 4
  v_readfirstlane_b32 s60, v124
  s_cmp_lt_u32 s60, 4
  s_cbranch_scc1 CA_31
  s_setprio 3
CA_31:
  v_mfma_f32_32x32x16_bf16 v[84:99], v[8:11], v[116:119], v[84:99]
  ds_read_b128 v[116:119], v6 offset:2112
  s_waitcnt lgkmcnt(1)
  v_mfma_f32_32x32x16_bf16 v[84:99], v[12:15], v[120:123], v[84:99]
  ds_read_b128 v[120:123], v6 offset:2144
  s_waitcnt lgkmcnt(1)
  v_mfma_f32_32x32x16_bf16 v[84:99], v[16:19], v[116:119], v[84:99]
  ds_read_b128 v[116:119], v6 offset:2176
  s_waitcnt lgkmcnt(1)
  v_mfma_f32_32x32x16_bf16 v[84:99], v[20:23], v[120:123], v[84:99]
  ds_read_b128 v[120:123], v6 offset:2208
  s_waitcnt lgkmcnt(1)
  ds_read_b32 v124, v125 offset:84
  v_mfma_f32_32x32x16_bf16 v[84:99], v[24:27], v[116:119], v[84:99]
  ds_read_b128 v[116:119], v6 offset:2240
  s_waitcnt lgkmcnt(1)
  v_mfma_f32_32x32x16_bf16 v[84:99], v[28:31], v[120:123], v[84:99]
  ds_read_b128 v[120:123], v6 offset:2272
  s_waitcnt lgkmcnt(1)
  v_mfma_f32_32x32x16_bf16 v[84:99], v[32:35], v[116:119], v[84:99]
  ds_read_b128 v[116:119], v6 offset:2304
  s_waitcnt lgkmcnt(1)
  v_mfma_f32_32x32x16_bf16 v[84:99], v[36:39], v[120:123], v[84:99]
  ds_read_b128 v[120:123], v6 offset:2336
  s_waitcnt lgkmcnt(1)
  v_readfirstlane_b32 s60, v124
  s_cmp_lt_u32 s60, 4
  s_cbranch_scc1 CA_32
  s_setprio 3
CA_32:
  v_mfma_f32_32x32x16_bf16 v[84:99], v[40:43], v[116:119], v[84:99]
  ds_read_b128 v[116:119], v6 offset:2368
  s_waitcnt lgkmcnt(1)
  v_mfma_f32_32x32x16_bf16 v[84:99], v[44:47], v[120:123], v[84:99]
  ds_read_b128 v[120:123], v6 offset:2400
  s_waitcnt lgkmcnt(1)
  v_mfma_f32_32x32x16_bf16 v[84:99], v[48:51], v[116:119], v[84:99]
  ds_read_b128 v[116:119], v6 offset:2432
  s_waitcnt lgkmcnt(1)
  v_mfma_f32_32x32x16_bf16 v[84:99], v[52:55], v[120:123], v[84:99]
  ds_read_b128 v[120:123], v6 offset:2464
  s_waitcnt lgkmcnt(1)
  ds_read_b32 v124, v125 offset:84
  v_mfma_f32_32x32x16_bf16 v[84:99], v[56:59], v[116:119], v[84:99]
  ds_read_b128 v[116:119], v6 offset:2496
  s_waitcnt lgkmcnt(1)
  v_mfma_f32_32x32x16_bf16 v[84:99], v[60:63], v[120:123], v[84:99]
  ds_read_b128 v[120:123], v6 offset:2528
  s_waitcnt lgkmcnt(1)
  v_mfma_f32_32x32x16_bf16 v[84:99], v[64:67], v[116:119], v[84:99]
  ds_read_b128 v[116:119], v6 offset:2560
  s_waitcnt lgkmcnt(1)
  v_mfma_f32_32x32x16_bf16 v[84:99], v[68:71], v[120:123], v[84:99]
  ds_read_b128 v[120:123], v6 offset:2592
  s_waitcnt lgkmcnt(1)
  s_nop 4
  v_readfirstlane_b32 s60, v124
  s_cmp_lt_u32 s60, 4
  s_cbranch_scc1 CA_33
  s_setprio 3
CA_33:
  v_mfma_f32_32x32x16_bf16 v[80:95], v[8:11], v[116:119], v[80:95]
  ds_read_b128 v[116:119], v6 offset:2624
  s_waitcnt lgkmcnt(1)
  v_mfma_f32_32x32x16_bf16 v[80:95], v[12:15], v[120:123], v[80:95]
  ds_read_b128 v[120:123], v6 offset:2656
  s_waitcnt lgkmcnt(1)
  v_mfma_f32_32x32x16_bf16 v[80:95], v[16:19], v[116:119], v[80:95]
  ds_read_b128 v[116:119], v6 offset:2688
  s_waitcnt lgkmcnt(1)
  v_mfma_f32_32x32x16_bf16 v[80:95], v[20:23], v[120:123], v[80:95]
  ds_read_b128 v[120:123], v6 offset:2720
  s_waitcnt lgkmcnt(1)
  ds_read_b32 v124, v125 offset:84
  v_mfma_f32_32x32x16_bf16 v[80:95], v[24:27], v[116:119], v[80:95]
  ds_read_b128 v[116:119], v6 offset:2752
  s_waitcnt lgkmcnt(1)
  v_mfma_f32_32x32x16_bf16 v[80:95], v[28:31], v[120:123], v[80:95]
  ds_read_b128 v[120:123], v6 offset:2784
  s_waitcnt lgkmcnt(1)
  v_mfma_f32_32x32x16_bf16 v[80:95], v[32:35], v[116:119], v[80:95]
  ds_read_b128 v[116:119], v6 offset:2816
  s_waitcnt lgkmcnt(1)
  v_mfma_f32_32x32x16_bf16 v[80:95], v[36:39], v[120:123], v[80:95]
  ds_read_b128 v[120:123], v6 offset:2848
  s_waitcnt lgkmcnt(1)
  v_readfirstlane_b32 s60, v124
  s_cmp_lt_u32 s60, 4
  s_cbranch_scc1 CA_34
  s_setprio 3
CA_34:
  v_mfma_f32_32x32x16_bf16 v[80:95], v[40:43], v[116:119], v[80:95]
  ds_read_b128 v[116:119], v6 offset:2880
  s_waitcnt lgkmcnt(1)
  v_mfma_f32_32x32x16_bf16 v[80:95], v[44:47], v[120:123], v[80:95]
  ds_read_b128 v[120:123], v6 offset:2912
  s_waitcnt lgkmcnt(1)
  v_mfma_f32_32x32x16_bf16 v[80:95], v[48:51], v[116:119], v[80:95]
  ds_read_b128 v[116:119], v6 offset:2944
  s_waitcnt lgkmcnt(1)
  v_mfma_f32_32x32x16_bf16 v[80:95], v[52:55], v[120:123], v[80:95]
  ds_read_b128 v[120:123], v6 offset:2976
  s_waitcnt lgkmcnt(1)
  ds_read_b32 v124, v125 offset:84
  v_mfma_f32_32x32x16_bf16 v[80:95], v[56:59], v[116:119], v[80:95]
  ds_read_b128 v[116:119], v6 offset:3008
  s_waitcnt lgkmcnt(1)
  v_mfma_f32_32x32x16_bf16 v[80:95], v[60:63], v[120:123], v[80:95]
  ds_read_b128 v[120:123], v6 offset:3040
  s_waitcnt lgkmcnt(1)
  v_mfma_f32_32x32x16_bf16 v[80:95], v[64:67], v[116:119], v[80:95]
  ds_read_b128 v[116:119], v6 offset:3072
  s_waitcnt lgkmcnt(1)
  v_mfma_f32_32x32x16_bf16 v[80:95], v[68:71], v[120:123], v[80:95]
  ds_read_b128 v[120:123], v6 offset:3104
  s_waitcnt lgkmcnt(1)
  s_nop 4
  v_readfirstlane_b32 s60, v124
  s_cmp_lt_u32 s60, 4
  s_cbranch_scc1 CA_35
  s_setprio 3
CA_35:
  v_mfma_f32_32x32x16_bf16 v[76:91], v[8:11], v[116:119], v[76:91]
  ds_read_b128 v[116:119], v6 offset:3136
  s_waitcnt lgkmcnt(1)
  v_mfma_f32_32x32x16_bf16 v[76:91], v[12:15], v[120:123], v[76:91]
  ds_read_b128 v[120:123], v6 offset:3168
  s_waitcnt lgkmcnt(1)
  v_mfma_f32_32x32x16_bf16 v[76:91], v[16:19], v[116:119], v[76:91]
  ds_read_b128 v[116:119], v6 offset:3200
  s_waitcnt lgkmcnt(1)
  v_mfma_f32_32x32x16_bf16 v[76:91], v[20:23], v[120:123], v[76:91]
  ds_read_b128 v[120:123], v6 offset:3232
  s_waitcnt lgkmcnt(1)
  ds_read_b32 v124, v125 offset:84
  v_mfma_f32_32x32x16_bf16 v[76:91], v[24:27], v[116:119], v[76:91]
  ds_read_b128 v[116:119], v6 offset:3264
  s_waitcnt lgkmcnt(1)
  v_mfma_f32_32x32x16_bf16 v[76:91], v[28:31], v[120:123], v[76:91]
  ds_read_b128 v[120:123], v6 offset:3296
  s_waitcnt lgkmcnt(1)
  v_mfma_f32_32x32x16_bf16 v[76:91], v[32:35], v[116:119], v[76:91]
  ds_read_b128 v[116:119], v6 offset:3328
  s_waitcnt lgkmcnt(1)
  v_mfma_f32_32x32x16_bf16 v[76:91], v[36:39], v[120:123], v[76:91]
  ds_read_b128 v[120:123], v6 offset:3360
  s_waitcnt lgkmcnt(1)
  v_readfirstlane_b32 s60, v124
  s_cmp_lt_u32 s60, 4
  s_cbranch_scc1 CA_36
  s_setprio 3
CA_36:
  v_mfma_f32_32x32x16_bf16 v[76:91], v[40:43], v[116:119], v[76:91]
  ds_read_b128 v[116:119], v6 offset:3392
  s_waitcnt lgkmcnt(1)
  v_mfma_f32_32x32x16_bf16 v[76:91], v[44:47], v[120:123], v[76:91]
  ds_read_b128 v[120:123], v6 offset:3424
  s_waitcnt lgkmcnt(1)
  v_mfma_f32_32x32x16_bf16 v[76:91], v[48:51], v[116:119], v[76:91]
  ds_read_b128 v[116:119], v6 offset:3456
  s_waitcnt lgkmcnt(1)
  v_mfma_f32_32x32x16_bf16 v[76:91], v[52:55], v[120:123], v[76:91]
  ds_read_b128 v[120:123], v6 offset:3488
  s_waitcnt lgkmcnt(1)
  ds_read_b32 v124, v125 offset:84
  v_mfma_f32_32x32x16_bf16 v[76:91], v[56:59], v[116:119], v[76:91]
  ds_read_b128 v[116:119], v6 offset:3520
  s_waitcnt lgkmcnt(1)
  v_mfma_f32_32x32x16_bf16 v[76:91], v[60:63], v[120:123], v[76:91]
  ds_read_b128 v[120:123], v6 offset:3552
  s_waitcnt lgkmcnt(1)
  v_mfma_f32_32x32x16_bf16 v[76:91], v[64:67], v[116:119], v[76:91]
  ds_read_b128 v[116:119], v6 offset:3584
  s_waitcnt lgkmcnt(1)
  v_mfma_f32_32x32x16_bf16 v[76:91], v[68:71], v[120:123], v[76:91]
  ds_read_b128 v[120:123], v6 offset:3616
  s_waitcnt lgkmcnt(1)
  s_nop 4
  v_readfirstlane_b32 s60, v124
  s_cmp_lt_u32 s60, 4
  s_cbranch_scc1 CA_37
  s_setprio 3
CA_37:
  v_mfma_f32_32x32x16_bf16 v[72:87], v[8:11], v[116:119], v[72:87]
  ds_read_b128 v[116:119], v6 offset:3648
  s_waitcnt lgkmcnt(1)
  v_mfma_f32_32x32x16_bf16 v[72:87], v[12:15], v[120:123], v[72:87]
  ds_read_b128 v[120:123], v6 offset:3680
  s_waitcnt lgkmcnt(1)
  v_mfma_f32_32x32x16_bf16 v[72:87], v[16:19], v[116:119], v[72:87]
  ds_read_b128 v[116:119], v6 offset:3712
  s_waitcnt lgkmcnt(1)
  v_mfma_f32_32x32x16_bf16 v[72:87], v[20:23], v[120:123], v[72:87]
  ds_read_b128 v[120:123], v6 offset:3744
  s_waitcnt lgkmcnt(1)
  ds_read_b32 v124, v125 offset:84
  v_mfma_f32_32x32x16_bf16 v[72:87], v[24:27], v[116:119], v[72:87]
  ds_read_b128 v[116:119], v6 offset:3776
  s_waitcnt lgkmcnt(1)
  v_mfma_f32_32x32x16_bf16 v[72:87], v[28:31], v[120:123], v[72:87]
  ds_read_b128 v[120:123], v6 offset:3808
  s_waitcnt lgkmcnt(1)
  v_mfma_f32_32x32x16_bf16 v[72:87], v[32:35], v[116:119], v[72:87]
  ds_read_b128 v[116:119], v6 offset:3840
  s_waitcnt lgkmcnt(1)
  v_mfma_f32_32x32x16_bf16 v[72:87], v[36:39], v[120:123], v[72:87]
  ds_read_b128 v[120:123], v6 offset:3872
  s_waitcnt lgkmcnt(1)
  v_readfirstlane_b32 s60, v124
  s_cmp_lt_u32 s60, 4
  s_cbranch_scc1 CA_38
  s_setprio 3
CA_38:
  v_mfma_f32_32x32x16_bf16 v[72:87], v[40:43], v[116:119], v[72:87]
  ds_read_b128 v[116:119], v6 offset:3904
  s_waitcnt lgkmcnt(1)
  v_mfma_f32_32x32x16_bf16 v[72:87], v[44:47], v[120:123], v[72:87]
  ds_read_b128 v[120:123], v6 offset:3936
  s_waitcnt lgkmcnt(1)
  v_mfma_f32_32x32x16_bf16 v[72:87], v[48:51], v[116:119], v[72:87]
  ds_read_b128 v[116:119], v6 offset:3968
  s_waitcnt lgkmcnt(1)
  v_mfma_f32_32x32x16_bf16 v[72:87], v[52:55], v[120:123], v[72:87]
  ds_read_b128 v[120:123], v6 offset:4000
  s_waitcnt lgkmcnt(1)
  ds_read_b32 v124, v125 offset:84
  v_mfma_f32_32x32x16_bf16 v[72:87], v[56:59], v[116:119], v[72:87]
  ds_read_b128 v[116:119], v6 offset:4032
  s_waitcnt lgkmcnt(1)
  v_mfma_f32_32x32x16_bf16 v[72:87], v[60:63], v[120:123], v[72:87]
  ds_read_b128 v[120:123], v6 offset:4064
  s_waitcnt lgkmcnt(1)
  v_mfma_f32_32x32x16_bf16 v[72:87], v[64:67], v[116:119], v[72:87]
  s_waitcnt lgkmcnt(0)
  v_mfma_f32_32x32x16_bf16 v[72:87], v[68:71], v[120:123], v[72:87]
  s_nop 11
  s_setprio 3
  v_cvt_pk_bf16_f32 v72, v72, v73
  v_cvt_pk_bf16_f32 v73, v74, v75
  v_cvt_pk_bf16_f32 v74, v76, v77
  v_cvt_pk_bf16_f32 v75, v78, v79
  v_cvt_pk_bf16_f32 v76, v80, v81
  v_cvt_pk_bf16_f32 v77, v82, v83
  v_cvt_pk_bf16_f32 v78, v84, v85
  v_cvt_pk_bf16_f32 v79, v86, v87
  v_cvt_pk_bf16_f32 v80, v88, v89
  v_cvt_pk_bf16_f32 v81, v90, v91
  v_cvt_pk_bf16_f32 v82, v92, v93
  v_cvt_pk_bf16_f32 v83, v94, v95
  v_cvt_pk_bf16_f32 v84, v96, v97
  v_cvt_pk_bf16_f32 v85, v98, v99
  v_cvt_pk_bf16_f32 v86, v100, v101
  v_cvt_pk_bf16_f32 v87, v102, v103
  buffer_store_dwordx4 v[72:75], v7, s[28:31], 0 offen offset:0 sc1
  buffer_store_dwordx4 v[76:79], v7, s[28:31], 0 offen offset:1024 sc1
  buffer_store_dwordx4 v[80:83], v7, s[28:31], 0 offen offset:2048 sc1
  buffer_store_dwordx4 v[84:87], v7, s[28:31], 0 offen offset:3072 sc1
  s_lshl_b32 s38, s23, 4
  s_mov_b64 s[50:51], 1
  s_branch L_CONVOUT
L_CONVQ:
  v_and_b32 v112, -4, v4
  v_and_b32 v113, -4, v5
  v_and_b32 v114, 2, v4
  v_lshlrev_b32 v114, 3, v114
  buffer_load_dwordx4 v[12:15], v112, s[44:47], 0 offen offset:0
  buffer_load_dword v101, v112, s[44:47], 0 offen offset:16
  buffer_load_dwordx4 v[16:19], v112, s[44:47], 0 offen offset:32
  buffer_load_dword v102, v112, s[44:47], 0 offen offset:48
  buffer_load_dwordx4 v[20:23], v112, s[44:47], 0 offen offset:64
  buffer_load_dword v103, v112, s[44:47], 0 offen offset:80
  buffer_load_dwordx4 v[24:27], v112, s[44:47], 0 offen offset:96
  buffer_load_dword v104, v112, s[44:47], 0 offen offset:112
  buffer_load_dwordx4 v[28:31], v112, s[44:47], 0 offen offset:128
  buffer_load_dword v105, v112, s[44:47], 0 offen offset:144
  buffer_load_dwordx4 v[32:35], v112, s[44:47], 0 offen offset:160
  buffer_load_dword v106, v112, s[44:47], 0 offen offset:176
  buffer_load_dwordx4 v[36:39], v112, s[44:47], 0 offen offset:192
  buffer_load_dword v107, v112, s[44:47], 0 offen offset:208
  buffer_load_dwordx4 v[40:43], v112, s[44:47], 0 offen offset:224
  buffer_load_dword v108, v112, s[44:47], 0 offen offset:240
  buffer_load_dwordx4 v[44:47], v112, s[44:47], 0 offen offset:256
  buffer_load_dword v109, v112, s[44:47], 0 offen offset:272
  buffer_load_dwordx4 v[48:51], v112, s[44:47], 0 offen offset:288
  buffer_load_dword v110, v112, s[44:47], 0 offen offset:304
  buffer_load_dwordx4 v[52:55], v112, s[44:47], 0 offen offset:320
  buffer_load_dword v111, v112, s[44:47], 0 offen offset:336
  buffer_load_dwordx4 v[56:59], v112, s[44:47], 0 offen offset:352
  buffer_load_dword v120, v112, s[44:47], 0 offen offset:368
  buffer_load_dwordx4 v[60:63], v112, s[44:47], 0 offen offset:384
  buffer_load_dword v121, v112, s[44:47], 0 offen offset:400
  buffer_load_dwordx4 v[64:67], v112, s[44:47], 0 offen offset:416
  buffer_load_dword v122, v112, s[44:47], 0 offen offset:432
  buffer_load_dwordx4 v[68:71], v112, s[44:47], 0 offen offset:448
  buffer_load_dword v123, v112, s[44:47], 0 offen offset:464
  buffer_load_dwordx4 v[8:11], v113, s[44:47], 0 offen offset:0
  buffer_load_dword v100, v113, s[44:47], 0 offen offset:16
  s_waitcnt vmcnt(0)
  s_setprio 3
  v_alignbit_b32 v8, v9, v8, v114
  v_alignbit_b32 v9, v10, v9, v114
  v_alignbit_b32 v10, v11, v10, v114
  v_alignbit_b32 v11, v100, v11, v114
  v_alignbit_b32 v12, v13, v12, v114
  v_alignbit_b32 v13, v14, v13, v114
  v_alignbit_b32 v14, v15, v14, v114
  v_alignbit_b32 v15, v101, v15, v114
  v_alignbit_b32 v16, v17, v16, v114
  v_alignbit_b32 v17, v18, v17, v114
  v_alignbit_b32 v18, v19, v18, v114
  v_alignbit_b32 v19, v102, v19, v114
  v_alignbit_b32 v20, v21, v20, v114
  v_alignbit_b32 v21, v22, v21, v114
  v_alignbit_b32 v22, v23, v22, v114
  v_alignbit_b32 v23, v103, v23, v114
  v_alignbit_b32 v24, v25, v24, v114
  v_alignbit_b32 v25, v26, v25, v114
  v_alignbit_b32 v26, v27, v26, v114
  v_alignbit_b32 v27, v104, v27, v114
  v_alignbit_b32 v28, v29, v28, v114
  v_alignbit_b32 v29, v30, v29, v114
  v_alignbit_b32 v30, v31, v30, v114
  v_alignbit_b32 v31, v105, v31, v114
  v_alignbit_b32 v32, v33, v32, v114
  v_alignbit_b32 v33, v34, v33, v114
  v_alignbit_b32 v34, v35, v34, v114
  v_alignbit_b32 v35, v106, v35, v114
  v_alignbit_b32 v36, v37, v36, v114
  v_alignbit_b32 v37, v38, v37, v114
  v_alignbit_b32 v38, v39, v38, v114
  v_alignbit_b32 v39, v107, v39, v114
  v_alignbit_b32 v40, v41, v40, v114
  v_alignbit_b32 v41, v42, v41, v114
  v_alignbit_b32 v42, v43, v42, v114
  v_alignbit_b32 v43, v108, v43, v114
  v_alignbit_b32 v44, v45, v44, v114
  v_alignbit_b32 v45, v46, v45, v114
  v_alignbit_b32 v46, v47, v46, v114
  v_alignbit_b32 v47, v109, v47, v114
  v_alignbit_b32 v48, v49, v48, v114
  v_alignbit_b32 v49, v50, v49, v114
  v_alignbit_b32 v50, v51, v50, v114
  v_alignbit_b32 v51, v110, v51, v114
  v_alignbit_b32 v52, v53, v52, v114
  v_alignbit_b32 v53, v54, v53, v114
  v_alignbit_b32 v54, v55, v54, v114
  v_alignbit_b32 v55, v111, v55, v114
  v_alignbit_b32 v56, v57, v56, v114
  v_alignbit_b32 v57, v58, v57, v114
  v_alignbit_b32 v58, v59, v58, v114
  v_alignbit_b32 v59, v120, v59, v114
  v_alignbit_b32 v60, v61, v60, v114
  v_alignbit_b32 v61, v62, v61, v114
  v_alignbit_b32 v62, v63, v62, v114
  v_alignbit_b32 v63, v121, v63, v114
  v_alignbit_b32 v64, v65, v64, v114
  v_alignbit_b32 v65, v66, v65, v114
  v_alignbit_b32 v66, v67, v66, v114
  v_alignbit_b32 v67, v122, v67, v114
  v_alignbit_b32 v68, v69, v68, v114
  v_alignbit_b32 v69, v70, v69, v114
  v_alignbit_b32 v70, v71, v70, v114
  v_alignbit_b32 v71, v123, v71, v114
  v_mov_b32 v72, 0
  v_mov_b32 v73, 0
  v_mov_b32 v74, 0
  v_mov_b32 v75, 0
  v_mov_b32 v76, 0
  v_mov_b32 v77, 0
  v_mov_b32 v78, 0
  v_mov_b32 v79, 0
  v_mov_b32 v80, 0
  v_mov_b32 v81, 0
  v_mov_b32 v82, 0
  v_mov_b32 v83, 0
  v_mov_b32 v84, 0
  v_mov_b32 v85, 0
  v_mov_b32 v86, 0
  v_mov_b32 v87, 0
  s_setprio 3
  s_lshl_b32 s37, s2, 7
  s_lshl_b32 s38, s22, 2
  s_add_u32 s37, s37, s38
LW_39:
  ds_read_b32 v127, v125 offset:108
  s_waitcnt lgkmcnt(0)
  v_readfirstlane_b32 s60, v127
  s_cmp_ge_u32 s60, 8
  s_cbranch_scc1 LW_39_d
  s_sleep 8
  s_branch LW_39
LW_39_d:
  s_mov_b32 exec_lo, 1
  s_mov_b32 exec_hi, 0
  s_mov_b32 s62, 0
GP_40:
  buffer_load_dword v127, v7, s[52:55], s37 offen offset:0 sc1
  s_add_u32 s62, s62, 1
  s_waitcnt vmcnt(0)
  v_cmp_ne_u32 vcc, s61, v127
  s_cmp_eq_u64 vcc, 0
  s_cbranch_scc1 GP_40_d
  s_mov_b64 exec, vcc
  s_cmp_ge_u32 s62, 32768
  s_cbranch_scc1 GP_40_d
  s_sleep 6
  s_branch GP_40
GP_40_d:
  s_mov_b64 exec, -1
  s_mov_b32 m0, s43
  s_movk_i32 s37, 6144
  s_mov_b32 s38, 0x100000
  buffer_load_dwordx4 v7, s[32:35], s37 offen offset:0 sc1 lds
  buffer_load_dwordx4 v7, s[32:35], s37 offen offset:1024 sc1 lds
  buffer_load_dwordx4 v7, s[32:35], 0 offen offset:2048 sc1 lds
  buffer_load_dwordx4 v7, s[32:35], 0 offen offset:3072 sc1 lds
  s_add_u32 m0, s43, 4096
  s_mov_b32 exec_hi, 0
  buffer_load_dwordx4 v7, s[32:35], s38 offen lds
  s_mov_b32 exec_hi, -1
  s_waitcnt vmcnt(0)
  s_setprio 0
  s_mov_b32 s41, 0
  s_movk_i32 s42, 4096
  s_add_u32 s44, s44, 4096
  s_addc_u32 s45, s45, 0
  v_add_u32 v6, 2048, v6
L_CONVQ2:
  ds_read_b128 v[116:119], v6 offset:0
  ds_read_b128 v[120:123], v6 offset:32
  s_waitcnt lgkmcnt(1)
  v_mfma_f32_32x32x16_bf16 v[84:99], v[8:11], v[116:119], v[84:99]
  ds_read_b128 v[116:119], v6 offset:64
  s_waitcnt lgkmcnt(1)
  v_mfma_f32_32x32x16_bf16 v[84:99], v[12:15], v[120:123], v[84:99]
  ds_read_b128 v[120:123], v6 offset:96
  s_waitcnt lgkmcnt(1)
  v_mfma_f32_32x32x16_bf16 v[84:99], v[16:19], v[116:119], v[84:99]
  ds_read_b128 v[116:119], v6 offset:128
  s_waitcnt lgkmcnt(1)
  v_mfma_f32_32x32x16_bf16 v[84:99], v[20:23], v[120:123], v[84:99]
  ds_read_b128 v[120:123], v6 offset:160
  s_waitcnt lgkmcnt(1)
  ds_read_b32 v124, v125 offset:84
  v_mfma_f32_32x32x16_bf16 v[84:99], v[24:27], v[116:119], v[84:99]
  ds_read_b128 v[116:119], v6 offset:192
  s_waitcnt lgkmcnt(1)
  v_mfma_f32_32x32x16_bf16 v[84:99], v[28:31], v[120:123], v[84:99]
  ds_read_b128 v[120:123], v6 offset:224
  s_waitcnt lgkmcnt(1)
  v_mfma_f32_32x32x16_bf16 v[84:99], v[32:35], v[116:119], v[84:99]
  ds_read_b128 v[116:119], v6 offset:256
  s_waitcnt lgkmcnt(1)
  v_mfma_f32_32x32x16_bf16 v[84:99], v[36:39], v[120:123], v[84:99]
  ds_read_b128 v[120:123], v6 offset:288
  s_waitcnt lgkmcnt(1)
  v_readfirstlane_b32 s60, v124
  s_cmp_lt_u32 s60, 4
  s_cbranch_scc1 CA_41
  s_setprio 3
CA_41:
  v_mfma_f32_32x32x16_bf16 v[84:99], v[40:43], v[116:119], v[84:99]
  ds_read_b128 v[116:119], v6 offset:320
  s_waitcnt lgkmcnt(1)
  v_mfma_f32_32x32x16_bf16 v[84:99], v[44:47], v[120:123], v[84:99]
  ds_read_b128 v[120:123], v6 offset:352
  s_waitcnt lgkmcnt(1)
  v_mfma_f32_32x32x16_bf16 v[84:99], v[48:51], v[116:119], v[84:99]
  ds_read_b128 v[116:119], v6 offset:384
  s_waitcnt lgkmcnt(1)
  v_mfma_f32_32x32x16_bf16 v[84:99], v[52:55], v[120:123], v[84:99]
  ds_read_b128 v[120:123], v6 offset:416
  s_waitcnt lgkmcnt(1)
  ds_read_b32 v124, v125 offset:84
  v_mfma_f32_32x32x16_bf16 v[84:99], v[56:59], v[116:119], v[84:99]
  ds_read_b128 v[116:119], v6 offset:448
  s_waitcnt lgkmcnt(1)
  v_mfma_f32_32x32x16_bf16 v[84:99], v[60:63], v[120:123], v[84:99]
  ds_read_b128 v[120:123], v6 offset:480
  s_waitcnt lgkmcnt(1)
  v_mfma_f32_32x32x16_bf16 v[84:99], v[64:67], v[116:119], v[84:99]
  ds_read_b128 v[116:119], v6 offset:512
  s_waitcnt lgkmcnt(1)
  v_mfma_f32_32x32x16_bf16 v[84:99], v[68:71], v[120:123], v[84:99]
  ds_read_b128 v[120:123], v6 offset:544
  s_waitcnt lgkmcnt(1)
  s_nop 4
  v_readfirstlane_b32 s60, v124
  s_cmp_lt_u32 s60, 4
  s_cbranch_scc1 CA_42
  s_setprio 3
CA_42:
  v_mfma_f32_32x32x16_bf16 v[80:95], v[8:11], v[116:119], v[80:95]
  ds_read_b128 v[116:119], v6 offset:576
  s_waitcnt lgkmcnt(1)
  v_mfma_f32_32x32x16_bf16 v[80:95], v[12:15], v[120:123], v[80:95]
  ds_read_b128 v[120:123], v6 offset:608
  s_waitcnt lgkmcnt(1)
  v_mfma_f32_32x32x16_bf16 v[80:95], v[16:19], v[116:119], v[80:95]
  ds_read_b128 v[116:119], v6 offset:640
  s_waitcnt lgkmcnt(1)
  v_mfma_f32_32x32x16_bf16 v[80:95], v[20:23], v[120:123], v[80:95]
  ds_read_b128 v[120:123], v6 offset:672
  s_waitcnt lgkmcnt(1)
  ds_read_b32 v124, v125 offset:84
  v_mfma_f32_32x32x16_bf16 v[80:95], v[24:27], v[116:119], v[80:95]
  ds_read_b128 v[116:119], v6 offset:704
  s_waitcnt lgkmcnt(1)
  v_mfma_f32_32x32x16_bf16 v[80:95], v[28:31], v[120:123], v[80:95]
  ds_read_b128 v[120:123], v6 offset:736
  s_waitcnt lgkmcnt(1)
  v_mfma_f32_32x32x16_bf16 v[80:95], v[32:35], v[116:119], v[80:95]
  ds_read_b128 v[116:119], v6 offset:768
  s_waitcnt lgkmcnt(1)
  v_mfma_f32_32x32x16_bf16 v[80:95], v[36:39], v[120:123], v[80:95]
  ds_read_b128 v[120:123], v6 offset:800
  s_waitcnt lgkmcnt(1)
  v_readfirstlane_b32 s60, v124
  s_cmp_lt_u32 s60, 4
  s_cbranch_scc1 CA_43
  s_setprio 3
CA_43:
  v_mfma_f32_32x32x16_bf16 v[80:95], v[40:43], v[116:119], v[80:95]
  ds_read_b128 v[116:119], v6 offset:832
  s_waitcnt lgkmcnt(1)
  v_mfma_f32_32x32x16_bf16 v[80:95], v[44:47], v[120:123], v[80:95]
  ds_read_b128 v[120:123], v6 offset:864
  s_waitcnt lgkmcnt(1)
  v_mfma_f32_32x32x16_bf16 v[80:95], v[48:51], v[116:119], v[80:95]
  ds_read_b128 v[116:119], v6 offset:896
  s_waitcnt lgkmcnt(1)
  v_mfma_f32_32x32x16_bf16 v[80:95], v[52:55], v[120:123], v[80:95]
  ds_read_b128 v[120:123], v6 offset:928
  s_waitcnt lgkmcnt(1)
  ds_read_b32 v124, v125 offset:84
  v_mfma_f32_32x32x16_bf16 v[80:95], v[56:59], v[116:119], v[80:95]
  ds_read_b128 v[116:119], v6 offset:960
  s_waitcnt lgkmcnt(1)
  v_mfma_f32_32x32x16_bf16 v[80:95], v[60:63], v[120:123], v[80:95]
  ds_read_b128 v[120:123], v6 offset:992
  s_waitcnt lgkmcnt(1)
  v_mfma_f32_32x32x16_bf16 v[80:95], v[64:67], v[116:119], v[80:95]
  ds_read_b128 v[116:119], v6 offset:1024
  s_waitcnt lgkmcnt(1)
  v_mfma_f32_32x32x16_bf16 v[80:95], v[68:71], v[120:123], v[80:95]
  ds_read_b128 v[120:123], v6 offset:1056
  s_waitcnt lgkmcnt(1)
  s_nop 4
  v_readfirstlane_b32 s60, v124
  s_cmp_lt_u32 s60, 4
  s_cbranch_scc1 CA_44
  s_setprio 3
CA_44:
  v_mfma_f32_32x32x16_bf16 v[76:91], v[8:11], v[116:119], v[76:91]
  ds_read_b128 v[116:119], v6 offset:1088
  s_waitcnt lgkmcnt(1)
  v_mfma_f32_32x32x16_bf16 v[76:91], v[12:15], v[120:123], v[76:91]
  ds_read_b128 v[120:123], v6 offset:1120
  s_waitcnt lgkmcnt(1)
  v_mfma_f32_32x32x16_bf16 v[76:91], v[16:19], v[116:119], v[76:91]
  ds_read_b128 v[116:119], v6 offset:1152
  s_waitcnt lgkmcnt(1)
  v_mfma_f32_32x32x16_bf16 v[76:91], v[20:23], v[120:123], v[76:91]
  ds_read_b128 v[120:123], v6 offset:1184
  s_waitcnt lgkmcnt(1)
  ds_read_b32 v124, v125 offset:84
  v_mfma_f32_32x32x16_bf16 v[76:91], v[24:27], v[116:119], v[76:91]
  ds_read_b128 v[116:119], v6 offset:1216
  s_waitcnt lgkmcnt(1)
  v_mfma_f32_32x32x16_bf16 v[76:91], v[28:31], v[120:123], v[76:91]
  ds_read_b128 v[120:123], v6 offset:1248
  s_waitcnt lgkmcnt(1)
  v_mfma_f32_32x32x16_bf16 v[76:91], v[32:35], v[116:119], v[76:91]
  ds_read_b128 v[116:119], v6 offset:1280
  s_waitcnt lgkmcnt(1)
  v_mfma_f32_32x32x16_bf16 v[76:91], v[36:39], v[120:123], v[76:91]
  ds_read_b128 v[120:123], v6 offset:1312
  s_waitcnt lgkmcnt(1)
  v_readfirstlane_b32 s60, v124
  s_cmp_lt_u32 s60, 4
  s_cbranch_scc1 CA_45
  s_setprio 3
CA_45:
  v_mfma_f32_32x32x16_bf16 v[76:91], v[40:43], v[116:119], v[76:91]
  ds_read_b128 v[116:119], v6 offset:1344
  s_waitcnt lgkmcnt(1)
  v_mfma_f32_32x32x16_bf16 v[76:91], v[44:47], v[120:123], v[76:91]
  ds_read_b128 v[120:123], v6 offset:1376
  s_waitcnt lgkmcnt(1)
  v_mfma_f32_32x32x16_bf16 v[76:91], v[48:51], v[116:119], v[76:91]
  ds_read_b128 v[116:119], v6 offset:1408
  s_waitcnt lgkmcnt(1)
  v_mfma_f32_32x32x16_bf16 v[76:91], v[52:55], v[120:123], v[76:91]
  ds_read_b128 v[120:123], v6 offset:1440
  s_waitcnt lgkmcnt(1)
  ds_read_b32 v124, v125 offset:84
  v_mfma_f32_32x32x16_bf16 v[76:91], v[56:59], v[116:119], v[76:91]
  ds_read_b128 v[116:119], v6 offset:1472
  s_waitcnt lgkmcnt(1)
  v_mfma_f32_32x32x16_bf16 v[76:91], v[60:63], v[120:123], v[76:91]
  ds_read_b128 v[120:123], v6 offset:1504
  s_waitcnt lgkmcnt(1)
  v_mfma_f32_32x32x16_bf16 v[76:91], v[64:67], v[116:119], v[76:91]
  ds_read_b128 v[116:119], v6 offset:1536
  s_waitcnt lgkmcnt(1)
  v_mfma_f32_32x32x16_bf16 v[76:91], v[68:71], v[120:123], v[76:91]
  ds_read_b128 v[120:123], v6 offset:1568
  s_waitcnt lgkmcnt(1)
  s_nop 4
  v_readfirstlane_b32 s60, v124
  s_cmp_lt_u32 s60, 4
  s_cbranch_scc1 CA_46
  s_setprio 3
CA_46:
  v_mfma_f32_32x32x16_bf16 v[72:87], v[8:11], v[116:119], v[72:87]
  ds_read_b128 v[116:119], v6 offset:1600
  buffer_load_dwordx4 v[8:11], v113, s[44:47], 0 offen offset:0
  buffer_load_dword v100, v113, s[44:47], 0 offen offset:16
  s_waitcnt lgkmcnt(1)
  v_mfma_f32_32x32x16_bf16 v[72:87], v[12:15], v[120:123], v[72:87]
  ds_read_b128 v[120:123], v6 offset:1632
  buffer_load_dwordx4 v[12:15], v113, s[44:47], 0 offen offset:32
  buffer_load_dword v101, v113, s[44:47], 0 offen offset:48
  s_waitcnt lgkmcnt(1)
  v_mfma_f32_32x32x16_bf16 v[72:87], v[16:19], v[116:119], v[72:87]
  ds_read_b128 v[116:119], v6 offset:1664
  buffer_load_dwordx4 v[16:19], v113, s[44:47], 0 offen offset:64
  buffer_load_dword v102, v113, s[44:47], 0 offen offset:80
  s_waitcnt lgkmcnt(1)
  v_mfma_f32_32x32x16_bf16 v[72:87], v[20:23], v[120:123], v[72:87]
  ds_read_b128 v[120:123], v6 offset:1696
  buffer_load_dwordx4 v[20:23], v113, s[44:47], 0 offen offset:96
  buffer_load_dword v103, v113, s[44:47], 0 offen offset:112
  s_waitcnt lgkmcnt(1)
  ds_read_b32 v124, v125 offset:84
  v_mfma_f32_32x32x16_bf16 v[72:87], v[24:27], v[116:119], v[72:87]
  ds_read_b128 v[116:119], v6 offset:1728
  buffer_load_dwordx4 v[24:27], v113, s[44:47], 0 offen offset:128
  buffer_load_dword v104, v113, s[44:47], 0 offen offset:144
  s_waitcnt lgkmcnt(1)
  v_mfma_f32_32x32x16_bf16 v[72:87], v[28:31], v[120:123], v[72:87]
  ds_read_b128 v[120:123], v6 offset:1760
  buffer_load_dwordx4 v[28:31], v113, s[44:47], 0 offen offset:160
  buffer_load_dword v105, v113, s[44:47], 0 offen offset:176
  s_waitcnt lgkmcnt(1)
  v_mfma_f32_32x32x16_bf16 v[72:87], v[32:35], v[116:119], v[72:87]
  ds_read_b128 v[116:119], v6 offset:1792
  buffer_load_dwordx4 v[32:35], v113, s[44:47], 0 offen offset:192
  buffer_load_dword v106, v113, s[44:47], 0 offen offset:208
  s_waitcnt lgkmcnt(1)
  v_mfma_f32_32x32x16_bf16 v[72:87], v[36:39], v[120:123], v[72:87]
  ds_read_b128 v[120:123], v6 offset:1824
  buffer_load_dwordx4 v[36:39], v113, s[44:47], 0 offen offset:224
  buffer_load_dword v107, v113, s[44:47], 0 offen offset:240
  s_waitcnt lgkmcnt(1)
  v_readfirstlane_b32 s60, v124
  s_cmp_lt_u32 s60, 4
  s_cbranch_scc1 CA_47
  s_setprio 3
CA_47:
  v_mfma_f32_32x32x16_bf16 v[72:87], v[40:43], v[116:119], v[72:87]
  ds_read_b128 v[116:119], v6 offset:1856
  buffer_load_dwordx4 v[40:43], v113, s[44:47], 0 offen offset:256
  buffer_load_dword v108, v113, s[44:47], 0 offen offset:272
  s_waitcnt lgkmcnt(1)
  v_mfma_f32_32x32x16_bf16 v[72:87], v[44:47], v[120:123], v[72:87]
  ds_read_b128 v[120:123], v6 offset:1888
  buffer_load_dwordx4 v[44:47], v113, s[44:47], 0 offen offset:288
  buffer_load_dword v109, v113, s[44:47], 0 offen offset:304
  s_waitcnt lgkmcnt(1)
  v_mfma_f32_32x32x16_bf16 v[72:87], v[48:51], v[116:119], v[72:87]
  ds_read_b128 v[116:119], v6 offset:1920
  buffer_load_dwordx4 v[48:51], v113, s[44:47], 0 offen offset:320
  buffer_load_dword v110, v113, s[44:47], 0 offen offset:336
  s_waitcnt lgkmcnt(1)
  v_mfma_f32_32x32x16_bf16 v[72:87], v[52:55], v[120:123], v[72:87]
  ds_read_b128 v[120:123], v6 offset:1952
  buffer_load_dwordx4 v[52:55], v113, s[44:47], 0 offen offset:352
  buffer_load_dword v111, v113, s[44:47], 0 offen offset:368
  s_waitcnt lgkmcnt(1)
  ds_read_b32 v124, v125 offset:84
  v_mfma_f32_32x32x16_bf16 v[72:87], v[56:59], v[116:119], v[72:87]
  ds_read_b128 v[116:119], v6 offset:1984
  s_waitcnt lgkmcnt(1)
  v_mfma_f32_32x32x16_bf16 v[72:87], v[60:63], v[120:123], v[72:87]
  ds_read_b128 v[120:123], v6 offset:2016
  s_waitcnt lgkmcnt(1)
  v_mfma_f32_32x32x16_bf16 v[72:87], v[64:67], v[116:119], v[72:87]
  s_waitcnt lgkmcnt(0)
  v_mfma_f32_32x32x16_bf16 v[72:87], v[68:71], v[120:123], v[72:87]
  buffer_load_dwordx4 v[56:59], v113, s[44:47], 0 offen offset:384
  buffer_load_dword v120, v113, s[44:47], 0 offen offset:400
  buffer_load_dwordx4 v[60:63], v113, s[44:47], 0 offen offset:416
  buffer_load_dword v121, v113, s[44:47], 0 offen offset:432
  buffer_load_dwordx4 v[64:67], v113, s[44:47], 0 offen offset:448
  buffer_load_dword v122, v113, s[44:47], 0 offen offset:464
  buffer_load_dwordx4 v[68:71], v113, s[44:47], 0 offen offset:480
  buffer_load_dword v123, v113, s[44:47], 0 offen offset:496
  s_nop 11
  s_setprio 3
  v_cvt_pk_bf16_f32 v72, v72, v73
  v_cvt_pk_bf16_f32 v73, v74, v75
  v_cvt_pk_bf16_f32 v74, v76, v77
  v_cvt_pk_bf16_f32 v75, v78, v79
  v_cvt_pk_bf16_f32 v76, v80, v81
  v_cvt_pk_bf16_f32 v77, v82, v83
  v_cvt_pk_bf16_f32 v78, v84, v85
  v_cvt_pk_bf16_f32 v79, v86, v87
  buffer_store_dwordx4 v[72:75], v7, s[28:31], s42 offen offset:0 sc1
  buffer_store_dwordx4 v[76:79], v7, s[28:31], s42 offen offset:1024 sc1
  s_cmp_eq_u32 s41, 1
  s_cbranch_scc1 L_CONVQD
  s_mov_b32 s41, 1
  s_movk_i32 s42, 10240
  s_mov_b32 s46, 0
  v_subrev_u32 v6, 2048, v6
  v_lshl_add_u32 v116, v2, 3, s43
  s_waitcnt vmcnt(2)
  v_alignbit_b32 v8, v9, v8, v114
  v_alignbit_b32 v9, v10, v9, v114
  v_alignbit_b32 v10, v11, v10, v114
  v_alignbit_b32 v11, v100, v11, v114
  v_alignbit_b32 v12, v13, v12, v114
  v_alignbit_b32 v13, v14, v13, v114
  v_alignbit_b32 v14, v15, v14, v114
  v_alignbit_b32 v15, v101, v15, v114
  v_alignbit_b32 v16, v17, v16, v114
  v_alignbit_b32 v17, v18, v17, v114
  v_alignbit_b32 v18, v19, v18, v114
  v_alignbit_b32 v19, v102, v19, v114
  v_alignbit_b32 v20, v21, v20, v114
  v_alignbit_b32 v21, v22, v21, v114
  v_alignbit_b32 v22, v23, v22, v114
  v_alignbit_b32 v23, v103, v23, v114
  v_alignbit_b32 v24, v25, v24, v114
  v_alignbit_b32 v25, v26, v25, v114
  v_alignbit_b32 v26, v27, v26, v114
  v_alignbit_b32 v27, v104, v27, v114
  v_alignbit_b32 v28, v29, v28, v114
  v_alignbit_b32 v29, v30, v29, v114
  v_alignbit_b32 v30, v31, v30, v114
  v_alignbit_b32 v31, v105, v31, v114
  v_alignbit_b32 v32, v33, v32, v114
  v_alignbit_b32 v33, v34, v33, v114
  v_alignbit_b32 v34, v35, v34, v114
  v_alignbit_b32 v35, v106, v35, v114
  v_alignbit_b32 v36, v37, v36, v114
  v_alignbit_b32 v37, v38, v37, v114
  v_alignbit_b32 v38, v39, v38, v114
  v_alignbit_b32 v39, v107, v39, v114
  v_alignbit_b32 v40, v41, v40, v114
  v_alignbit_b32 v41, v42, v41, v114
  v_alignbit_b32 v42, v43, v42, v114
  v_alignbit_b32 v43, v108, v43, v114
  v_alignbit_b32 v44, v45, v44, v114
  v_alignbit_b32 v45, v46, v45, v114
  v_alignbit_b32 v46, v47, v46, v114
  v_alignbit_b32 v47, v109, v47, v114
  v_alignbit_b32 v48, v49, v48, v114
  v_alignbit_b32 v49, v50, v49, v114
  v_alignbit_b32 v50, v51, v50, v114
  v_alignbit_b32 v51, v110, v51, v114
  v_alignbit_b32 v52, v53, v52, v114
  v_alignbit_b32 v53, v54, v53, v114
  v_alignbit_b32 v54, v55, v54, v114
  v_alignbit_b32 v55, v111, v55, v114
  v_alignbit_b32 v56, v57, v56, v114
  v_alignbit_b32 v57, v58, v57, v114
  v_alignbit_b32 v58, v59, v58, v114
  v_alignbit_b32 v59, v120, v59, v114
  v_alignbit_b32 v60, v61, v60, v114
  v_alignbit_b32 v61, v62, v61, v114
  v_alignbit_b32 v62, v63, v62, v114
  v_alignbit_b32 v63, v121, v63, v114
  v_alignbit_b32 v64, v65, v64, v114
  v_alignbit_b32 v65, v66, v65, v114
  v_alignbit_b32 v66, v67, v66, v114
  v_alignbit_b32 v67, v122, v67, v114
  v_alignbit_b32 v68, v69, v68, v114
  v_alignbit_b32 v69, v70, v69, v114
  v_alignbit_b32 v70, v71, v70, v114
  v_alignbit_b32 v71, v123, v71, v114
  v_mov_b32 v72, 0
  v_mov_b32 v73, 0
  v_mov_b32 v74, 0
  v_mov_b32 v75, 0
  v_mov_b32 v76, 0
  v_mov_b32 v77, 0
  v_mov_b32 v78, 0
  v_mov_b32 v79, 0
  v_mov_b32 v80, 0
  v_mov_b32 v81, 0
  v_mov_b32 v82, 0
  v_mov_b32 v83, 0
  v_mov_b32 v84, 0
  v_mov_b32 v85, 0
  v_mov_b32 v86, 0
  v_mov_b32 v87, 0
  ds_write_b64 v116, v[72:73] offset:2048
  s_waitcnt lgkmcnt(0)
  s_cmp_ge_u32 s60, 4
  s_cbranch_scc1 L_CONVQ2
  s_setprio 0
  s_branch L_CONVQ2
L_CONVQD:
  s_lshl_b32 s38, s23, 4
  s_add_u32 s38, s38, 1024
  s_mov_b64 s[50:51], 3
L_CONVOUT:
  v_mov_b32 v125, 161280
  v_mov_b32 v126, 1
  v_mov_b32 v127, s61
  v_lshlrev_b32 v124, 4, v2
  s_mov_b64 exec, s[50:51]
  s_waitcnt vmcnt(0)
  buffer_store_dword v127, v124, s[24:27], s38 offen sc1
  s_mov_b64 exec, -1
L_CONVNONE:
  s_mov_b64 exec, 1
  ds_add_u32 v125, v126 offset:96
  s_mov_b64 exec, -1
  s_load_dwordx2 s[10:11], s[0:1], 88
  s_mul_i32 s36, s16, 73728
  s_add_u32 s36, s36, 655360
  s_add_u32 s24, s4, s36
  s_addc_u32 s25, s5, 0
  s_mov_b32 s26, 73728
  s_mov_b32 s27, 0x20000
  s_lshl_b32 s36, s16, 10
  s_add_u32 s36, s36, 262144
  s_add_u32 s28, s4, s36
  s_addc_u32 s29, s5, 0
  s_mov_b32 s30, 1024
  s_mov_b32 s31, 0x20000
  s_add_u32 s41, s18, 4
  s_cmp_eq_u32 s18, 2
  s_cselect_b32 s41, 7, s41
  s_mov_b32 s49, 0xff00
  s_cselect_b32 s49, 0, s49
  s_cmp_eq_u32 s18, 3
  s_cselect_b32 s46, 1, 3
  s_movk_i32 s47, 0xff
  s_cselect_b32 s47, s47, 0xffff
  s_mov_b32 s50, s47
  s_add_u32 s36, s17, 2
  s_add_u32 s42, s36, s18
  s_and_b32 s42, s42, 7
  s_add_u32 s43, s36, s41
  s_and_b32 s43, s43, 7
  v_lshlrev_b32 v4, 4, v2
  v_mov_b32 v5, s42
  v_mov_b32 v6, s43
  v_cmp_gt_u32 vcc, 8, v2
  v_and_b32 v7, 7, v2
  v_lshlrev_b32 v7, 4, v7
  v_cndmask_b32 v5, v6, v5, vcc
  v_lshl_add_u32 v5, v5, 7, v7
  v_mov_b32 v24, 8
  s_mul_i32 s42, s42, 9216
  s_mul_i32 s43, s43, 9216
  s_mul_i32 s44, s18, 9216
  s_add_u32 s44, s44, 87552
  s_mul_i32 s45, s41, 9216
  s_add_u32 s45, s45, 87552
  s_lshl_b32 s36, s18, 2
  v_add_u32 v6, s36, v125
  s_lshl_b32 s36, s41, 2
  v_add_u32 v7, s36, v125
  s_lshr_b32 s38, s18, 1
  s_and_b32 s39, s18, 1
  s_mov_b32 s40, 4
  v_lshrrev_b32 v23, 4, v2
  v_and_b32 v22, 15, v2
  v_and_b32 v16, 12, v2
  v_lshl_add_u32 v16, v3, 4, v16
  v_and_b32 v17, 1, v23
  v_lshl_add_u32 v16, v17, 1, v16
  v_mul_u32_u24 v16, 144, v16
  v_and_b32 v17, 3, v2
  v_lshl_add_u32 v16, v17, 3, v16
  s_lshl_b32 s22, s40, 5
  v_add_u32 v16, s22, v16
  v_add_u32 v17, 41472, v16
  v_lshlrev_b32 v21, 4, v22
  v_lshl_add_u32 v18, v23, 9, v21
  s_lshl_b32 s22, s38, 12
  s_add_u32 s22, s22, 87552
  s_lshl_b32 s23, s38, 9
  s_add_u32 s23, s23, 95744
  s_lshl_b32 s60, s39, 8
  s_add_u32 s22, s22, s60
  s_add_u32 s23, s23, s60
  v_add_u32 v18, s22, v18
  v_add_u32 v19, 36864, v18
  v_mul_u32_u24 v20, 9216, v23
  v_add3_u32 v20, v20, v21, s23
  v_mul_u32_u24 v22, 2304, v22
  v_lshl_add_u32 v22, v23, 3, v22
  v_and_b32 v21, 7, v2
  v_lshl_add_u32 v21, v21, 2, v125
  v_mov_b32 v8, 0
  v_mov_b32 v9, 0
  v_mov_b32 v10, 0
  v_mov_b32 v11, 0
  v_mov_b32 v12, 0
  v_mov_b32 v13, 0
  v_mov_b32 v14, 0
  v_mov_b32 v15, 0
  s_lshl_b32 s22, s16, 2
  s_add_u32 s22, s22, s18
  s_mul_i32 s22, s22, 36864
  s_mul_i32 s23, s17, 144
  s_add_u32 s22, s22, s23
  s_add_u32 s22, s22, 1280
LW_48:
  ds_read_b32 v127, v125 offset:76
  s_waitcnt lgkmcnt(0)
  v_readfirstlane_b32 s60, v127
  s_cmp_ge_u32 s60, 1
  s_cbranch_scc1 LW_48_d
  s_sleep 4
  s_branch LW_48
LW_48_d:
  s_add_u32 s32, s10, s22
  s_addc_u32 s33, s11, 0
  s_mov_b32 s34, 34576
  s_mov_b32 s35, 0x20000
  ds_read_b64_tr_b16 v[52:53], v16 offset:0
  ds_read_b64_tr_b16 v[54:55], v16 offset:144
  ds_read_b64_tr_b16 v[56:57], v16 offset:4608
  ds_read_b64_tr_b16 v[58:59], v16 offset:4752
  ds_read_b64_tr_b16 v[60:61], v16 offset:9216
  ds_read_b64_tr_b16 v[62:63], v16 offset:9360
  ds_read_b64_tr_b16 v[64:65], v16 offset:13824
  ds_read_b64_tr_b16 v[66:67], v16 offset:13968
  ds_read_b64_tr_b16 v[68:69], v16 offset:18432
  ds_read_b64_tr_b16 v[70:71], v16 offset:18576
  ds_read_b64_tr_b16 v[72:73], v16 offset:23040
  ds_read_b64_tr_b16 v[74:75], v16 offset:23184
  ds_read_b64_tr_b16 v[76:77], v16 offset:27648
  ds_read_b64_tr_b16 v[78:79], v16 offset:27792
  ds_read_b64_tr_b16 v[80:81], v16 offset:32256
  ds_read_b64_tr_b16 v[82:83], v16 offset:32400
  ds_read_b64_tr_b16 v[84:85], v16 offset:36864
  ds_read_b64_tr_b16 v[86:87], v16 offset:37008
  ds_read_b64_tr_b16 v[88:89], v17 offset:0
  ds_read_b64_tr_b16 v[90:91], v17 offset:144
  ds_read_b64_tr_b16 v[92:93], v17 offset:4608
  ds_read_b64_tr_b16 v[94:95], v17 offset:4752
  ds_read_b64_tr_b16 v[96:97], v17 offset:9216
  ds_read_b64_tr_b16 v[98:99], v17 offset:9360
  ds_read_b64_tr_b16 v[100:101], v17 offset:13824
  ds_read_b64_tr_b16 v[102:103], v17 offset:13968
  ds_read_b64_tr_b16 v[104:105], v17 offset:18432
  ds_read_b64_tr_b16 v[106:107], v17 offset:18576
  ds_read_b64_tr_b16 v[108:109], v17 offset:23040
  ds_read_b64_tr_b16 v[110:111], v17 offset:23184
  ds_read_b64_tr_b16 v[112:113], v17 offset:27648
  ds_read_b64_tr_b16 v[114:115], v17 offset:27792
  ds_read_b64_tr_b16 v[116:117], v17 offset:32256
  ds_read_b64_tr_b16 v[118:119], v17 offset:32400
  ds_read_b64_tr_b16 v[120:121], v17 offset:36864
  ds_read_b64_tr_b16 v[122:123], v17 offset:37008
LW_49:
  ds_read_b32 v127, v125 offset:116
  s_waitcnt lgkmcnt(0)
  v_readfirstlane_b32 s60, v127
  s_cmp_ge_u32 s60, 8
  s_cbranch_scc1 LW_49_d
  s_sleep 4
  s_branch LW_49
LW_49_d:
  s_mov_b32 s62, 0
  s_mov_b32 s50, 0
  s_mov_b32 exec_hi, 0
  v_cmp_eq_u32 vcc, 0, v2
  s_nop 1
  v_cndmask_b32 v6, v7, v6, vcc
L_GL:
  s_or_b32 exec_lo, s47, 1
  buffer_load_dword v25, v5, s[28:31], 0 offen sc1
  ds_read_b32 v127, v125 offset:80
  s_add_u32 s62, s62, 1
  s_cmp_eq_u32 s50, 0
  s_cbranch_scc1 L_GNP
  s_mov_b32 exec_lo, s50
  s_waitcnt vmcnt(1)
  ds_add_u32 v6, v24 offset:128
  s_mov_b32 s50, 0
  s_or_b32 exec_lo, s47, 1
L_GNP:
  s_waitcnt vmcnt(0) lgkmcnt(0)
  v_cmp_ne_u32 vcc, s61, v25
  v_readfirstlane_b32 s60, v127
  s_and_b32 s47, s47, vcc_lo
  s_cmp_ge_u32 s62, 32768
  s_cselect_b32 s47, 0, s47
  s_cmp_ge_u32 s60, 8
  s_cselect_b32 s49, 0, s49
  s_or_b32 s48, s47, s49
  s_and_b32 s37, s48, 255
  s_cbranch_scc1 L_GW0
  s_bitcmp1_b32 s46, 0
  s_cbranch_scc0 L_GW0
  s_mov_b64 exec, -1
  s_add_u32 m0, s44, 0
  s_add_u32 s37, s42, 0
  buffer_load_dwordx4 v4, s[24:27], s37 offen offset:0 sc1 lds
  buffer_load_dwordx4 v4, s[24:27], s37 offen offset:1024 sc1 lds
  buffer_load_dwordx4 v4, s[24:27], s37 offen offset:2048 sc1 lds
  buffer_load_dwordx4 v4, s[24:27], s37 offen offset:3072 sc1 lds
  s_add_u32 m0, s44, 4096
  s_add_u32 s37, s42, 4096
  buffer_load_dwordx4 v4, s[24:27], s37 offen offset:0 sc1 lds
  buffer_load_dwordx4 v4, s[24:27], s37 offen offset:1024 sc1 lds
  buffer_load_dwordx4 v4, s[24:27], s37 offen offset:2048 sc1 lds
  buffer_load_dwordx4 v4, s[24:27], s37 offen offset:3072 sc1 lds
  s_add_u32 m0, s44, 8192
  s_add_u32 s37, s42, 8192
  buffer_load_dwordx4 v4, s[24:27], s37 offen offset:0 sc1 lds
  s_bitset0_b32 s46, 0
  s_bitset1_b32 s50, 0
  s_mov_b32 exec_hi, 0
L_GW0:
  s_and_b32 s37, s48, 65280
  s_cbranch_scc1 L_GW1
  s_bitcmp1_b32 s46, 1
  s_cbranch_scc0 L_GW1
  s_mov_b64 exec, -1
  s_add_u32 m0, s45, 0
  s_add_u32 s37, s43, 0
  buffer_load_dwordx4 v4, s[24:27], s37 offen offset:0 sc1 lds
  buffer_load_dwordx4 v4, s[24:27], s37 offen offset:1024 sc1 lds
  buffer_load_dwordx4 v4, s[24:27], s37 offen offset:2048 sc1 lds
  buffer_load_dwordx4 v4, s[24:27], s37 offen offset:3072 sc1 lds
  s_add_u32 m0, s45, 4096
  s_add_u32 s37, s43, 4096
  buffer_load_dwordx4 v4, s[24:27], s37 offen offset:0 sc1 lds
  buffer_load_dwordx4 v4, s[24:27], s37 offen offset:1024 sc1 lds
  buffer_load_dwordx4 v4, s[24:27], s37 offen offset:2048 sc1 lds
  buffer_load_dwordx4 v4, s[24:27], s37 offen offset:3072 sc1 lds
  s_add_u32 m0, s45, 8192
  s_add_u32 s37, s43, 8192
  buffer_load_dwordx4 v4, s[24:27], s37 offen offset:0 sc1 lds
  s_bitset0_b32 s46, 1
  s_bitset1_b32 s50, 1
  s_mov_b32 exec_hi, 0
L_GW1:
  s_cmp_lg_u32 s46, 0
  s_cbranch_scc1 L_GL
  s_cmp_lg_u32 s50, 3
  s_cbranch_scc1 L_GP1
  s_mov_b32 exec_lo, 1
  s_waitcnt vmcnt(9)
  ds_add_u32 v6, v24 offset:128
  s_mov_b32 s50, 2
L_GP1:
  s_mov_b32 exec_lo, s50
  s_waitcnt vmcnt(0)
  ds_add_u32 v6, v24 offset:128
  s_mov_b64 exec, -1
L_GD:
  ds_read_b32 v127, v21 offset:128
  s_waitcnt lgkmcnt(0)
  v_cmp_gt_u32 vcc, 8, v127
  s_cmp_eq_u64 vcc, 0
  s_cbranch_scc1 L_GG
  s_sleep 1
  s_branch L_GD
L_GG:
  ds_read_b128 v[28:31], v18 offset:0
  ds_read_b128 v[32:35], v18 offset:2048
  ds_read_b128 v[36:39], v18 offset:9216
  ds_read_b128 v[40:43], v18 offset:11264
  ds_read_b128 v[44:47], v18 offset:18432
  ds_read_b128 v[48:51], v18 offset:20480
  s_waitcnt lgkmcnt(5)
  v_mfma_f32_16x16x32_bf16 v[8:11], v[52:55], v[28:31], v[8:11]
  ds_read_b128 v[28:31], v18 offset:27648
  s_waitcnt lgkmcnt(5)
  v_mfma_f32_16x16x32_bf16 v[8:11], v[56:59], v[32:35], v[8:11]
  ds_read_b128 v[32:35], v18 offset:29696
  s_waitcnt lgkmcnt(5)
  v_mfma_f32_16x16x32_bf16 v[8:11], v[60:63], v[36:39], v[8:11]
  ds_read_b128 v[36:39], v19 offset:0
  s_waitcnt lgkmcnt(5)
  v_mfma_f32_16x16x32_bf16 v[8:11], v[64:67], v[40:43], v[8:11]
  ds_read_b128 v[40:43], v19 offset:2048
  s_waitcnt lgkmcnt(5)
  v_mfma_f32_16x16x32_bf16 v[8:11], v[68:71], v[44:47], v[8:11]
  ds_read_b128 v[44:47], v19 offset:9216
  s_waitcnt lgkmcnt(5)
  v_mfma_f32_16x16x32_bf16 v[8:11], v[72:75], v[48:51], v[8:11]
  ds_read_b128 v[48:51], v19 offset:11264
  s_waitcnt lgkmcnt(5)
  v_mfma_f32_16x16x32_bf16 v[8:11], v[76:79], v[28:31], v[8:11]
  ds_read_b128 v[28:31], v19 offset:18432
  s_waitcnt lgkmcnt(5)
  v_mfma_f32_16x16x32_bf16 v[8:11], v[80:83], v[32:35], v[8:11]
  ds_read_b128 v[32:35], v19 offset:20480
  s_waitcnt lgkmcnt(5)
  v_mfma_f32_16x16x32_bf16 v[8:11], v[84:87], v[36:39], v[8:11]
  ds_read_b128 v[36:39], v19 offset:27648
  s_waitcnt lgkmcnt(5)
  v_mfma_f32_16x16x32_bf16 v[8:11], v[88:91], v[40:43], v[8:11]
  ds_read_b128 v[40:43], v19 offset:29696
  s_waitcnt lgkmcnt(5)
  v_mfma_f32_16x16x32_bf16 v[8:11], v[92:95], v[44:47], v[8:11]
  ds_read_b128 v[44:47], v20 offset:0
  s_waitcnt lgkmcnt(5)
  v_mfma_f32_16x16x32_bf16 v[8:11], v[96:99], v[48:51], v[8:11]
  ds_read_b128 v[48:51], v20 offset:36864
  s_waitcnt lgkmcnt(5)
  v_mfma_f32_16x16x32_bf16 v[8:11], v[100:103], v[28:31], v[8:11]
  s_waitcnt lgkmcnt(4)
  v_mfma_f32_16x16x32_bf16 v[8:11], v[104:107], v[32:35], v[8:11]
  s_waitcnt lgkmcnt(3)
  v_mfma_f32_16x16x32_bf16 v[8:11], v[108:111], v[36:39], v[8:11]
  s_waitcnt lgkmcnt(2)
  v_mfma_f32_16x16x32_bf16 v[8:11], v[112:115], v[40:43], v[8:11]
  s_waitcnt lgkmcnt(1)
  v_mfma_f32_16x16x32_bf16 v[8:11], v[116:119], v[44:47], v[8:11]
  s_waitcnt lgkmcnt(0)
  v_mfma_f32_16x16x32_bf16 v[8:11], v[120:123], v[48:51], v[8:11]
  s_nop 7
  v_cvt_pk_bf16_f32 v24, v8, v9
  v_cvt_pk_bf16_f32 v25, v10, v11
  s_mov_b32 exec_hi, 0
  buffer_store_dwordx2 v[24:25], v22, s[32:35], 0 offen
  s_endpgm
L_LOADER:
  s_memrealtime s[36:37]
  s_load_dwordx2 s[44:45], s[0:1], 80
  v_mov_b32 v4, 0
  v_lshl_add_u32 v5, v2, 2, v125
  ds_write_b32 v5, v4
  v_lshlrev_b32 v6, 7, v2
  s_movk_i32 s21, 7282
  v_add_u32 v10, 512, v2
  v_mul_u32_u24 v11, s21, v10
  v_lshrrev_b32 v11, 16, v11
  v_mul_u32_u24 v12, 9, v11
  v_sub_u32 v12, v10, v12
  v_lshlrev_b32 v12, 4, v12
  v_and_b32 v13, 3, v11
  v_bfe_u32 v14, v11, 2, 2
  v_lshl_add_u32 v13, v13, 2, v14
  v_lshrrev_b32 v11, 4, v11
  v_lshl_add_u32 v13, v11, 4, v13
  v_mul_u32_u24 v13, 1152, v13
  v_add_u32 v42, v13, v12
  s_mul_i32 s21, s17, 144
  s_sub_u32 s22, 663552, s21
  s_waitcnt lgkmcnt(0)
  s_mov_b32 s24, s4
  s_mov_b32 s25, s5
  s_mov_b32 s26, 256
  s_mov_b32 s27, 0x20000
  s_cmp_lg_u32 s2, 0
  s_cbranch_scc1 L_NONONCE
  s_or_b32 s36, s36, 1
  v_mov_b32 v7, s36
  s_mov_b64 exec, 3
  buffer_store_dword v7, v6, s[24:27], 0 offen sc1
  s_mov_b64 exec, -1
L_NONONCE:
  s_mov_b32 s4, s6
  s_mov_b32 s5, s7
  s_add_u32 s48, s10, s21
  s_addc_u32 s49, s11, 0
  s_mov_b32 s50, s22
  s_mov_b32 s51, 0x20000
  s_add_u32 s40, s44, s21
  s_addc_u32 s41, s45, 0
  s_mov_b32 s42, s22
  s_mov_b32 s43, 0x20000
  s_lshl_b32 s36, s20, 1
  s_add_u32 s36, s36, s17
  s_sub_u32 s37, s36, 9
  s_cmp_ge_u32 s36, 9
  s_cselect_b32 s36, s37, s36
  s_barrier
  s_mov_b32 m0, 104960
  s_mul_i32 s38, s36, 73728
  buffer_load_dwordx4 v42, s[48:51], s38 offen lds
  s_add_u32 s36, s36, 1
  s_cmp_eq_u32 s36, 9
  s_cselect_b32 s36, 0, s36
  s_mov_b32 m0, 114176
  s_mul_i32 s38, s36, 73728
  buffer_load_dwordx4 v42, s[48:51], s38 offen lds
  s_add_u32 s36, s36, 1
  s_cmp_eq_u32 s36, 9
  s_cselect_b32 s36, 0, s36
  s_mov_b32 m0, 123392
  s_mul_i32 s38, s36, 73728
  buffer_load_dwordx4 v42, s[48:51], s38 offen lds
  s_add_u32 s36, s36, 1
  s_cmp_eq_u32 s36, 9
  s_cselect_b32 s36, 0, s36
  s_mov_b32 m0, 132608
  s_mul_i32 s38, s36, 73728
  buffer_load_dwordx4 v42, s[48:51], s38 offen lds
  s_add_u32 s36, s36, 1
  s_cmp_eq_u32 s36, 9
  s_cselect_b32 s36, 0, s36
  s_mov_b32 m0, 141824
  s_mul_i32 s38, s36, 73728
  buffer_load_dwordx4 v42, s[48:51], s38 offen lds
  s_add_u32 s36, s36, 1
  s_cmp_eq_u32 s36, 9
  s_cselect_b32 s36, 0, s36
  s_mov_b32 m0, 151040
  s_mul_i32 s38, s36, 73728
  buffer_load_dwordx4 v42, s[48:51], s38 offen lds
  s_add_u32 s36, s36, 1
  s_cmp_eq_u32 s36, 9
  s_cselect_b32 s36, 0, s36
  s_mov_b32 m0, 160256
  s_mul_i32 s38, s36, 73728
  buffer_load_dwordx4 v42, s[48:51], s38 offen lds
  s_add_u32 s36, s36, 1
  s_cmp_eq_u32 s36, 9
  s_cselect_b32 s36, 0, s36
  v_lshlrev_b32 v8, 4, v2
  s_and_b32 s21, s2, 1
  s_lshl_b32 s21, s21, 7
  v_mov_b32 v6, s21
  buffer_load_dword v7, v6, s[24:27], 0 offen sc1
  s_mov_b32 s28, s4
  s_mov_b32 s29, s5
  s_mov_b32 s30, 151552
  s_mov_b32 s31, 0x20000
  s_and_b32 s21, s2, 7
  s_lshl_b32 s21, s21, 11
  s_add_u32 s21, s21, 196608
  s_add_u32 s32, s4, s21
  s_addc_u32 s33, s5, 0
  s_mov_b32 s34, 2048
  s_mov_b32 s35, 0x20000
  s_waitcnt vmcnt(7)
  s_mov_b64 exec, 1
  ds_add_u32 v125, v126 offset:0
  s_mov_b64 exec, -1
  s_waitcnt vmcnt(6)
  s_mov_b64 exec, 1
  ds_add_u32 v125, v126 offset:4
  s_mov_b64 exec, -1
  s_waitcnt vmcnt(5)
  s_mov_b64 exec, 1
  ds_add_u32 v125, v126 offset:8
  s_mov_b64 exec, -1
  s_waitcnt vmcnt(4)
  s_mov_b64 exec, 1
  ds_add_u32 v125, v126 offset:12
  s_mov_b64 exec, -1
  s_waitcnt vmcnt(3)
  s_mov_b64 exec, 1
  ds_add_u32 v125, v126 offset:16
  s_mov_b64 exec, -1
  s_waitcnt vmcnt(2)
  s_mov_b64 exec, 1
  ds_add_u32 v125, v126 offset:20
  s_mov_b64 exec, -1
  s_waitcnt vmcnt(1)
  s_mov_b64 exec, 1
  ds_add_u32 v125, v126 offset:24
  s_mov_b64 exec, -1
  s_mov_b32 s62, 0
L_NP:
  s_add_u32 s62, s62, 1
  s_waitcnt vmcnt(0)
  v_readfirstlane_b32 s61, v7
  s_cmp_lg_u32 s61, 0
  s_cbranch_scc1 L_NPD
  s_mov_b32 s61, 1
  s_cmp_ge_u32 s62, 32768
  s_cbranch_scc1 L_NPD
  s_sleep 4
  buffer_load_dword v7, v6, s[24:27], 0 offen sc1
  s_branch L_NP
L_NPD:
  v_mov_b32 v127, s61
  s_mov_b64 exec, 1
  ds_write_b32 v125, v127 offset:52
  s_mov_b64 exec, -1
  s_movk_i32 s21, 7282
  s_lshl_b32 s23, s17, 2
  s_add_u32 s23, s23, 8
  v_add_u32 v10, 0, v2
  v_mul_u32_u24 v11, s21, v10
  v_lshrrev_b32 v11, 16, v11
  v_mul_u32_u24 v44, 9, v11
  v_sub_u32 v44, v10, v44
  v_lshlrev_b32 v44, 4, v44
  v_and_b32 v45, 3, v11
  v_bfe_u32 v46, v11, 2, 2
  v_lshl_add_u32 v45, v45, 2, v46
  v_lshrrev_b32 v11, 4, v11
  v_mul_u32_u24 v46, 18, v11
  v_add_u32 v46, v46, v45
  v_mul_u32_u24 v46, 1152, v46
  v_add_u32 v20, v46, v44
  v_lshrrev_b32 v46, 1, v45
  v_lshl_add_u32 v46, v11, 3, v46
  v_add_u32 v46, s23, v46
  v_and_b32 v46, 31, v46
  v_mul_u32_u24 v46, 18, v46
  v_and_b32 v45, 1, v45
  v_add3_u32 v46, v46, v45, 16
  v_mul_u32_u24 v46, 1152, v46
  v_add_u32 v30, v46, v44
  v_add_u32 v10, 64, v2
  v_mul_u32_u24 v11, s21, v10
  v_lshrrev_b32 v11, 16, v11
  v_mul_u32_u24 v44, 9, v11
  v_sub_u32 v44, v10, v44
  v_lshlrev_b32 v44, 4, v44
  v_and_b32 v45, 3, v11
  v_bfe_u32 v46, v11, 2, 2
  v_lshl_add_u32 v45, v45, 2, v46
  v_lshrrev_b32 v11, 4, v11
  v_subrev_u32 v44, 1024, v44
  v_mul_u32_u24 v46, 18, v11
  v_add_u32 v46, v46, v45
  v_mul_u32_u24 v46, 1152, v46
  v_add_u32 v21, v46, v44
  v_lshrrev_b32 v46, 1, v45
  v_lshl_add_u32 v46, v11, 3, v46
  v_add_u32 v46, s23, v46
  v_and_b32 v46, 31, v46
  v_mul_u32_u24 v46, 18, v46
  v_and_b32 v45, 1, v45
  v_add3_u32 v46, v46, v45, 16
  v_mul_u32_u24 v46, 1152, v46
  v_add_u32 v31, v46, v44
  v_add_u32 v10, 128, v2
  v_mul_u32_u24 v11, s21, v10
  v_lshrrev_b32 v11, 16, v11
  v_mul_u32_u24 v44, 9, v11
  v_sub_u32 v44, v10, v44
  v_lshlrev_b32 v44, 4, v44
  v_and_b32 v45, 3, v11
  v_bfe_u32 v46, v11, 2, 2
  v_lshl_add_u32 v45, v45, 2, v46
  v_lshrrev_b32 v11, 4, v11
  v_subrev_u32 v44, 2048, v44
  v_mul_u32_u24 v46, 18, v11
  v_add_u32 v46, v46, v45
  v_mul_u32_u24 v46, 1152, v46
  v_add_u32 v22, v46, v44
  v_lshrrev_b32 v46, 1, v45
  v_lshl_add_u32 v46, v11, 3, v46
  v_add_u32 v46, s23, v46
  v_and_b32 v46, 31, v46
  v_mul_u32_u24 v46, 18, v46
  v_and_b32 v45, 1, v45
  v_add3_u32 v46, v46, v45, 16
  v_mul_u32_u24 v46, 1152, v46
  v_add_u32 v32, v46, v44
  v_add_u32 v10, 192, v2
  v_mul_u32_u24 v11, s21, v10
  v_lshrrev_b32 v11, 16, v11
  v_mul_u32_u24 v44, 9, v11
  v_sub_u32 v44, v10, v44
  v_lshlrev_b32 v44, 4, v44
  v_and_b32 v45, 3, v11
  v_bfe_u32 v46, v11, 2, 2
  v_lshl_add_u32 v45, v45, 2, v46
  v_lshrrev_b32 v11, 4, v11
  v_subrev_u32 v44, 3072, v44
  v_mul_u32_u24 v46, 18, v11
  v_add_u32 v46, v46, v45
  v_mul_u32_u24 v46, 1152, v46
  v_add_u32 v23, v46, v44
  v_lshrrev_b32 v46, 1, v45
  v_lshl_add_u32 v46, v11, 3, v46
  v_add_u32 v46, s23, v46
  v_and_b32 v46, 31, v46
  v_mul_u32_u24 v46, 18, v46
  v_and_b32 v45, 1, v45
  v_add3_u32 v46, v46, v45, 16
  v_mul_u32_u24 v46, 1152, v46
  v_add_u32 v33, v46, v44
  v_add_u32 v10, 256, v2
  v_mul_u32_u24 v11, s21, v10
  v_lshrrev_b32 v11, 16, v11
  v_mul_u32_u24 v44, 9, v11
  v_sub_u32 v44, v10, v44
  v_lshlrev_b32 v44, 4, v44
  v_and_b32 v45, 3, v11
  v_bfe_u32 v46, v11, 2, 2
  v_lshl_add_u32 v45, v45, 2, v46
  v_lshrrev_b32 v11, 4, v11
  v_mul_u32_u24 v46, 18, v11
  v_add_u32 v46, v46, v45
  v_mul_u32_u24 v46, 1152, v46
  v_add_u32 v24, v46, v44
  v_lshrrev_b32 v46, 1, v45
  v_lshl_add_u32 v46, v11, 3, v46
  v_add_u32 v46, s23, v46
  v_and_b32 v46, 31, v46
  v_mul_u32_u24 v46, 18, v46
  v_and_b32 v45, 1, v45
  v_add3_u32 v46, v46, v45, 16
  v_mul_u32_u24 v46, 1152, v46
  v_add_u32 v34, v46, v44
  v_add_u32 v10, 320, v2
  v_mul_u32_u24 v11, s21, v10
  v_lshrrev_b32 v11, 16, v11
  v_mul_u32_u24 v44, 9, v11
  v_sub_u32 v44, v10, v44
  v_lshlrev_b32 v44, 4, v44
  v_and_b32 v45, 3, v11
  v_bfe_u32 v46, v11, 2, 2
  v_lshl_add_u32 v45, v45, 2, v46
  v_lshrrev_b32 v11, 4, v11
  v_subrev_u32 v44, 1024, v44
  v_mul_u32_u24 v46, 18, v11
  v_add_u32 v46, v46, v45
  v_mul_u32_u24 v46, 1152, v46
  v_add_u32 v25, v46, v44
  v_lshrrev_b32 v46, 1, v45
  v_lshl_add_u32 v46, v11, 3, v46
  v_add_u32 v46, s23, v46
  v_and_b32 v46, 31, v46
  v_mul_u32_u24 v46, 18, v46
  v_and_b32 v45, 1, v45
  v_add3_u32 v46, v46, v45, 16
  v_mul_u32_u24 v46, 1152, v46
  v_add_u32 v35, v46, v44
  v_add_u32 v10, 384, v2
  v_mul_u32_u24 v11, s21, v10
  v_lshrrev_b32 v11, 16, v11
  v_mul_u32_u24 v44, 9, v11
  v_sub_u32 v44, v10, v44
  v_lshlrev_b32 v44, 4, v44
  v_and_b32 v45, 3, v11
  v_bfe_u32 v46, v11, 2, 2
  v_lshl_add_u32 v45, v45, 2, v46
  v_lshrrev_b32 v11, 4, v11
  v_subrev_u32 v44, 2048, v44
  v_mul_u32_u24 v46, 18, v11
  v_add_u32 v46, v46, v45
  v_mul_u32_u24 v46, 1152, v46
  v_add_u32 v26, v46, v44
  v_lshrrev_b32 v46, 1, v45
  v_lshl_add_u32 v46, v11, 3, v46
  v_add_u32 v46, s23, v46
  v_and_b32 v46, 31, v46
  v_mul_u32_u24 v46, 18, v46
  v_and_b32 v45, 1, v45
  v_add3_u32 v46, v46, v45, 16
  v_mul_u32_u24 v46, 1152, v46
  v_add_u32 v36, v46, v44
  v_add_u32 v10, 448, v2
  v_mul_u32_u24 v11, s21, v10
  v_lshrrev_b32 v11, 16, v11
  v_mul_u32_u24 v44, 9, v11
  v_sub_u32 v44, v10, v44
  v_lshlrev_b32 v44, 4, v44
  v_and_b32 v45, 3, v11
  v_bfe_u32 v46, v11, 2, 2
  v_lshl_add_u32 v45, v45, 2, v46
  v_lshrrev_b32 v11, 4, v11
  v_subrev_u32 v44, 3072, v44
  v_mul_u32_u24 v46, 18, v11
  v_add_u32 v46, v46, v45
  v_mul_u32_u24 v46, 1152, v46
  v_add_u32 v27, v46, v44
  v_lshrrev_b32 v46, 1, v45
  v_lshl_add_u32 v46, v11, 3, v46
  v_add_u32 v46, s23, v46
  v_and_b32 v46, 31, v46
  v_mul_u32_u24 v46, 18, v46
  v_and_b32 v45, 1, v45
  v_add3_u32 v46, v46, v45, 16
  v_mul_u32_u24 v46, 1152, v46
  v_add_u32 v37, v46, v44
  v_add_u32 v10, 512, v2
  v_mul_u32_u24 v11, s21, v10
  v_lshrrev_b32 v11, 16, v11
  v_mul_u32_u24 v44, 9, v11
  v_sub_u32 v44, v10, v44
  v_lshlrev_b32 v44, 4, v44
  v_and_b32 v45, 3, v11
  v_bfe_u32 v46, v11, 2, 2
  v_lshl_add_u32 v45, v45, 2, v46
  v_lshrrev_b32 v11, 4, v11
  v_mul_u32_u24 v46, 18, v11
  v_add_u32 v46, v46, v45
  v_mul_u32_u24 v46, 1152, v46
  v_add_u32 v28, v46, v44
  v_lshrrev_b32 v46, 1, v45
  v_lshl_add_u32 v46, v11, 3, v46
  v_add_u32 v46, s23, v46
  v_and_b32 v46, 31, v46
  v_mul_u32_u24 v46, 18, v46
  v_and_b32 v45, 1, v45
  v_add3_u32 v46, v46, v45, 16
  v_mul_u32_u24 v46, 1152, v46
  v_add_u32 v38, v46, v44
LW_50:
  ds_read_b32 v127, v125 offset:36
  s_waitcnt lgkmcnt(0)
  v_readfirstlane_b32 s60, v127
  s_cmp_ge_u32 s60, 8
  s_cbranch_scc1 LW_50_d
  s_sleep 1
  s_branch LW_50
LW_50_d:
  s_mov_b32 m0, 104960
  s_mul_i32 s38, s36, 73728
  buffer_load_dwordx4 v42, s[48:51], s38 offen lds
  s_add_u32 s36, s36, 1
  s_cmp_eq_u32 s36, 9
  s_cselect_b32 s36, 0, s36
LW_51:
  ds_read_b32 v127, v125 offset:40
  s_waitcnt lgkmcnt(0)
  v_readfirstlane_b32 s60, v127
  s_cmp_ge_u32 s60, 8
  s_cbranch_scc1 LW_51_d
  s_sleep 1
  s_branch LW_51
LW_51_d:
  s_mov_b32 m0, 114176
  s_mul_i32 s38, s36, 73728
  buffer_load_dwordx4 v42, s[48:51], s38 offen lds
  s_waitcnt vmcnt(1)
  s_mov_b64 exec, 1
  ds_add_u32 v125, v126 offset:28
  s_mov_b64 exec, -1
  s_waitcnt vmcnt(0)
  s_mov_b64 exec, 1
  ds_add_u32 v125, v126 offset:32
  s_mov_b64 exec, -1
LW_52:
  ds_read_b32 v127, v125 offset:120
  s_waitcnt lgkmcnt(0)
  v_readfirstlane_b32 s60, v127
  s_cmp_ge_u32 s60, 1
  s_cbranch_scc1 LW_52_d
  s_sleep 1
  s_branch LW_52
LW_52_d:
  s_mov_b32 s62, 0
  s_mov_b64 s[22:23], -1
  s_mov_b64 s[38:39], -1
L_KP:
  s_mov_b64 exec, s[22:23]
  s_cbranch_execz L_KP1
  buffer_load_dwordx2 v[14:15], v8, s[32:35], 0 offen sc1
L_KP1:
  s_mov_b64 exec, s[38:39]
  s_cbranch_execz L_KP2
  buffer_load_dwordx2 v[16:17], v8, s[32:35], 0 offen offset:1024 sc1
L_KP2:
  s_mov_b64 exec, -1
  s_add_u32 s62, s62, 1
  s_waitcnt vmcnt(0)
  v_cmp_ne_u32 s[22:23], s61, v14
  v_cmp_ne_u32 s[38:39], s61, v16
  s_or_b64 vcc, s[22:23], s[38:39]
  s_cmp_eq_u64 vcc, 0
  s_cbranch_scc1 L_KPD
  s_cmp_ge_u32 s62, 32768
  s_cbranch_scc1 L_KPD
  s_sleep 2
  s_branch L_KP
L_KPD:
  s_mov_b32 m0, 0
  s_nop 0
  buffer_load_dwordx4 v8, s[28:31], m0 offen offset:0 sc1 lds
  buffer_load_dwordx4 v8, s[28:31], m0 offen offset:1024 sc1 lds
  buffer_load_dwordx4 v8, s[28:31], m0 offen offset:2048 sc1 lds
  buffer_load_dwordx4 v8, s[28:31], m0 offen offset:3072 sc1 lds
  s_mov_b32 m0, 4096
  s_nop 0
  buffer_load_dwordx4 v8, s[28:31], m0 offen offset:0 sc1 lds
  buffer_load_dwordx4 v8, s[28:31], m0 offen offset:1024 sc1 lds
  buffer_load_dwordx4 v8, s[28:31], m0 offen offset:2048 sc1 lds
  buffer_load_dwordx4 v8, s[28:31], m0 offen offset:3072 sc1 lds
  s_mov_b32 m0, 8192
  s_nop 0
  buffer_load_dwordx4 v8, s[28:31], m0 offen offset:0 sc1 lds
  buffer_load_dwordx4 v8, s[28:31], m0 offen offset:1024 sc1 lds
  v_max_u32 v15, v15, v17
  s_nop 1
  v_max_u32_dpp v15, v15, v15 row_ror:8 row_mask:0xf bank_mask:0xf
  s_nop 1
  v_max_u32_dpp v15, v15, v15 row_ror:4 row_mask:0xf bank_mask:0xf
  s_nop 1
  v_max_u32_dpp v15, v15, v15 row_ror:2 row_mask:0xf bank_mask:0xf
  s_nop 1
  v_max_u32_dpp v15, v15, v15 row_ror:1 row_mask:0xf bank_mask:0xf
  s_nop 0
  v_readlane_b32 s36, v15, 0
  v_readlane_b32 s37, v15, 16
  v_readlane_b32 s38, v15, 32
  v_readlane_b32 s39, v15, 48
  s_max_u32 s36, s36, s37
  s_max_u32 s38, s38, s39
  s_max_u32 s36, s36, s38
  v_mov_b32 v127, s36
  s_mov_b64 exec, 1
  ds_write_b32 v125, v127 offset:60
  s_mov_b64 exec, -1
  buffer_load_dwordx4 v8, s[28:31], m0 offen offset:2048 sc1 lds
  buffer_load_dwordx4 v8, s[28:31], m0 offen offset:3072 sc1 lds
  s_waitcnt vmcnt(2)
  v_mov_b32 v127, 2
  s_mov_b64 exec, 1
  ds_write_b32 v125, v127 offset:56
  s_mov_b64 exec, -1
  s_mov_b32 m0, 12288
  s_nop 0
  buffer_load_dwordx4 v8, s[28:31], m0 offen offset:0 sc1 lds
  buffer_load_dwordx4 v8, s[28:31], m0 offen offset:1024 sc1 lds
  buffer_load_dwordx4 v8, s[28:31], m0 offen offset:2048 sc1 lds
  buffer_load_dwordx4 v8, s[28:31], m0 offen offset:3072 sc1 lds
  s_mov_b32 m0, 16384
  s_nop 0
  buffer_load_dwordx4 v8, s[28:31], m0 offen offset:0 sc1 lds
  buffer_load_dwordx4 v8, s[28:31], m0 offen offset:1024 sc1 lds
  buffer_load_dwordx4 v8, s[28:31], m0 offen offset:2048 sc1 lds
  buffer_load_dwordx4 v8, s[28:31], m0 offen offset:3072 sc1 lds
  s_mov_b32 m0, 20480
  s_nop 0
  buffer_load_dwordx4 v8, s[28:31], m0 offen offset:0 sc1 lds
  buffer_load_dwordx4 v8, s[28:31], m0 offen offset:1024 sc1 lds
  s_waitcnt vmcnt(3)
  v_mov_b32 v127, 4
  s_mov_b64 exec, 1
  ds_write_b32 v125, v127 offset:56
  s_mov_b64 exec, -1
LW_53:
  ds_read_b32 v127, v125 offset:48
  s_waitcnt lgkmcnt(0)
  v_readfirstlane_b32 s60, v127
  s_cmp_ge_u32 s60, 8
  s_cbranch_scc0 LW_53
  buffer_load_dwordx4 v8, s[28:31], m0 offen offset:2048 sc1 lds
  buffer_load_dwordx4 v8, s[28:31], m0 offen offset:3072 sc1 lds
  s_waitcnt vmcnt(8)
  s_mov_b32 m0, 24576
  s_nop 0
  buffer_load_dwordx4 v8, s[28:31], m0 offen offset:0 sc1 lds
  buffer_load_dwordx4 v8, s[28:31], m0 offen offset:1024 sc1 lds
  buffer_load_dwordx4 v8, s[28:31], m0 offen offset:2048 sc1 lds
  buffer_load_dwordx4 v8, s[28:31], m0 offen offset:3072 sc1 lds
  s_waitcnt vmcnt(8)
  s_mov_b32 m0, 28672
  s_nop 0
  buffer_load_dwordx4 v8, s[28:31], m0 offen offset:0 sc1 lds
  buffer_load_dwordx4 v8, s[28:31], m0 offen offset:1024 sc1 lds
  buffer_load_dwordx4 v8, s[28:31], m0 offen offset:2048 sc1 lds
  buffer_load_dwordx4 v8, s[28:31], m0 offen offset:3072 sc1 lds
  s_waitcnt vmcnt(8)
  s_mov_b32 m0, 32768
  s_nop 0
  buffer_load_dwordx4 v8, s[28:31], m0 offen offset:0 sc1 lds
  buffer_load_dwordx4 v8, s[28:31], m0 offen offset:1024 sc1 lds
  buffer_load_dwordx4 v8, s[28:31], m0 offen offset:2048 sc1 lds
  buffer_load_dwordx4 v8, s[28:31], m0 offen offset:3072 sc1 lds
  s_waitcnt vmcnt(8)
  v_mov_b32 v127, 6
  s_mov_b64 exec, 1
  ds_write_b32 v125, v127 offset:56
  s_mov_b64 exec, -1
  s_mov_b32 m0, 36864
  s_nop 0
  buffer_load_dwordx4 v8, s[28:31], m0 offen offset:0 sc1 lds
  buffer_load_dwordx4 v8, s[28:31], m0 offen offset:1024 sc1 lds
  buffer_load_dwordx4 v8, s[28:31], m0 offen offset:2048 sc1 lds
  buffer_load_dwordx4 v8, s[28:31], m0 offen offset:3072 sc1 lds
  s_waitcnt vmcnt(8)
  s_mov_b32 m0, 40960
  s_nop 0
  buffer_load_dwordx4 v8, s[28:31], m0 offen offset:0 sc1 lds
  buffer_load_dwordx4 v8, s[28:31], m0 offen offset:1024 sc1 lds
  buffer_load_dwordx4 v8, s[28:31], m0 offen offset:2048 sc1 lds
  buffer_load_dwordx4 v8, s[28:31], m0 offen offset:3072 sc1 lds
  s_waitcnt vmcnt(8)
  s_mov_b32 m0, 45056
  s_nop 0
  buffer_load_dwordx4 v8, s[28:31], m0 offen offset:0 sc1 lds
  buffer_load_dwordx4 v8, s[28:31], m0 offen offset:1024 sc1 lds
  buffer_load_dwordx4 v8, s[28:31], m0 offen offset:2048 sc1 lds
  buffer_load_dwordx4 v8, s[28:31], m0 offen offset:3072 sc1 lds
  s_waitcnt vmcnt(8)
  v_mov_b32 v127, 8
  s_mov_b64 exec, 1
  ds_write_b32 v125, v127 offset:56
  s_mov_b64 exec, -1
  s_mov_b32 m0, 49152
  s_nop 0
  buffer_load_dwordx4 v8, s[28:31], m0 offen offset:0 sc1 lds
  buffer_load_dwordx4 v8, s[28:31], m0 offen offset:1024 sc1 lds
  buffer_load_dwordx4 v8, s[28:31], m0 offen offset:2048 sc1 lds
  buffer_load_dwordx4 v8, s[28:31], m0 offen offset:3072 sc1 lds
  s_waitcnt vmcnt(8)
  s_mov_b32 m0, 53248
  s_nop 0
  buffer_load_dwordx4 v8, s[28:31], m0 offen offset:0 sc1 lds
  buffer_load_dwordx4 v8, s[28:31], m0 offen offset:1024 sc1 lds
  buffer_load_dwordx4 v8, s[28:31], m0 offen offset:2048 sc1 lds
  buffer_load_dwordx4 v8, s[28:31], m0 offen offset:3072 sc1 lds
  s_waitcnt vmcnt(8)
  v_mov_b32 v127, 10
  s_mov_b64 exec, 1
  ds_write_b32 v125, v127 offset:56
  s_mov_b64 exec, -1
  s_mov_b32 m0, 57344
  s_nop 0
  buffer_load_dwordx4 v8, s[28:31], m0 offen offset:0 sc1 lds
  buffer_load_dwordx4 v8, s[28:31], m0 offen offset:1024 sc1 lds
  buffer_load_dwordx4 v8, s[28:31], m0 offen offset:2048 sc1 lds
  buffer_load_dwordx4 v8, s[28:31], m0 offen offset:3072 sc1 lds
  s_waitcnt vmcnt(8)
  s_mov_b32 m0, 61440
  s_nop 0
  buffer_load_dwordx4 v8, s[28:31], m0 offen offset:0 sc1 lds
  buffer_load_dwordx4 v8, s[28:31], m0 offen offset:1024 sc1 lds
  buffer_load_dwordx4 v8, s[28:31], m0 offen offset:2048 sc1 lds
  buffer_load_dwordx4 v8, s[28:31], m0 offen offset:3072 sc1 lds
  s_waitcnt vmcnt(8)
  s_mov_b32 m0, 65536
  s_nop 0
  buffer_load_dwordx4 v8, s[28:31], m0 offen offset:0 sc1 lds
  buffer_load_dwordx4 v8, s[28:31], m0 offen offset:1024 sc1 lds
  buffer_load_dwordx4 v8, s[28:31], m0 offen offset:2048 sc1 lds
  buffer_load_dwordx4 v8, s[28:31], m0 offen offset:3072 sc1 lds
  s_waitcnt vmcnt(8)
  s_mov_b32 m0, 69632
  s_nop 0
  buffer_load_dwordx4 v8, s[28:31], m0 offen offset:0 sc1 lds
  buffer_load_dwordx4 v8, s[28:31], m0 offen offset:1024 sc1 lds
  buffer_load_dwordx4 v8, s[28:31], m0 offen offset:2048 sc1 lds
  buffer_load_dwordx4 v8, s[28:31], m0 offen offset:3072 sc1 lds
  s_waitcnt vmcnt(8)
  s_mov_b32 m0, 73728
  s_nop 0
  buffer_load_dwordx4 v8, s[28:31], m0 offen offset:0 sc1 lds
  buffer_load_dwordx4 v8, s[28:31], m0 offen offset:1024 sc1 lds
  buffer_load_dwordx4 v8, s[28:31], m0 offen offset:2048 sc1 lds
  buffer_load_dwordx4 v8, s[28:31], m0 offen offset:3072 sc1 lds
  s_waitcnt vmcnt(8)
  v_mov_b32 v127, 14
  s_mov_b64 exec, 1
  ds_write_b32 v125, v127 offset:56
  s_mov_b64 exec, -1
  s_mov_b32 m0, 77824
  s_nop 0
  buffer_load_dwordx4 v8, s[28:31], m0 offen offset:0 sc1 lds
  buffer_load_dwordx4 v8, s[28:31], m0 offen offset:1024 sc1 lds
  buffer_load_dwordx4 v8, s[28:31], m0 offen offset:2048 sc1 lds
  buffer_load_dwordx4 v8, s[28:31], m0 offen offset:3072 sc1 lds
  s_waitcnt vmcnt(8)
  s_mov_b32 m0, 81920
  s_nop 0
  buffer_load_dwordx4 v8, s[28:31], m0 offen offset:0 sc1 lds
  buffer_load_dwordx4 v8, s[28:31], m0 offen offset:1024 sc1 lds
  buffer_load_dwordx4 v8, s[28:31], m0 offen offset:2048 sc1 lds
  buffer_load_dwordx4 v8, s[28:31], m0 offen offset:3072 sc1 lds
  s_waitcnt vmcnt(8)
  s_mov_b32 m0, 86016
  s_nop 0
  buffer_load_dwordx4 v8, s[28:31], m0 offen offset:0 sc1 lds
  buffer_load_dwordx4 v8, s[28:31], m0 offen offset:1024 sc1 lds
  buffer_load_dwordx4 v8, s[28:31], m0 offen offset:2048 sc1 lds
  buffer_load_dwordx4 v8, s[28:31], m0 offen offset:3072 sc1 lds
  s_waitcnt vmcnt(8)
  s_mov_b32 m0, 90112
  s_nop 0
  buffer_load_dwordx4 v8, s[28:31], m0 offen offset:0 sc1 lds
  buffer_load_dwordx4 v8, s[28:31], m0 offen offset:1024 sc1 lds
  buffer_load_dwordx4 v8, s[28:31], m0 offen offset:2048 sc1 lds
  buffer_load_dwordx4 v8, s[28:31], m0 offen offset:3072 sc1 lds
  s_waitcnt vmcnt(8)
  v_mov_b32 v127, 18
  s_mov_b64 exec, 1
  ds_write_b32 v125, v127 offset:56
  s_mov_b64 exec, -1
  s_mov_b32 m0, 94208
  s_nop 0
  buffer_load_dwordx4 v8, s[28:31], m0 offen offset:0 sc1 lds
  buffer_load_dwordx4 v8, s[28:31], m0 offen offset:1024 sc1 lds
  buffer_load_dwordx4 v8, s[28:31], m0 offen offset:2048 sc1 lds
  buffer_load_dwordx4 v8, s[28:31], m0 offen offset:3072 sc1 lds
  s_waitcnt vmcnt(8)
  s_mov_b32 m0, 98304
  s_nop 0
  buffer_load_dwordx4 v8, s[28:31], m0 offen offset:0 sc1 lds
  buffer_load_dwordx4 v8, s[28:31], m0 offen offset:1024 sc1 lds
  buffer_load_dwordx4 v8, s[28:31], m0 offen offset:2048 sc1 lds
  buffer_load_dwordx4 v8, s[28:31], m0 offen offset:3072 sc1 lds
  s_waitcnt vmcnt(8)
  s_mov_b32 m0, 102400
  s_nop 0
  buffer_load_dwordx4 v8, s[28:31], m0 offen offset:0 sc1 lds
  buffer_load_dwordx4 v8, s[28:31], m0 offen offset:1024 sc1 lds
  buffer_load_dwordx4 v8, s[28:31], m0 offen offset:2048 sc1 lds
  buffer_load_dwordx4 v8, s[28:31], m0 offen offset:3072 sc1 lds
  s_waitcnt vmcnt(8)
  s_mov_b32 m0, 106496
  s_nop 0
  buffer_load_dwordx4 v8, s[28:31], m0 offen offset:0 sc1 lds
  buffer_load_dwordx4 v8, s[28:31], m0 offen offset:1024 sc1 lds
  buffer_load_dwordx4 v8, s[28:31], m0 offen offset:2048 sc1 lds
  buffer_load_dwordx4 v8, s[28:31], m0 offen offset:3072 sc1 lds
  s_waitcnt vmcnt(8)
  s_mov_b32 m0, 110592
  s_nop 0
  buffer_load_dwordx4 v8, s[28:31], m0 offen offset:0 sc1 lds
  buffer_load_dwordx4 v8, s[28:31], m0 offen offset:1024 sc1 lds
  buffer_load_dwordx4 v8, s[28:31], m0 offen offset:2048 sc1 lds
  buffer_load_dwordx4 v8, s[28:31], m0 offen offset:3072 sc1 lds
  s_waitcnt vmcnt(8)
  v_mov_b32 v127, 22
  s_mov_b64 exec, 1
  ds_write_b32 v125, v127 offset:56
  s_mov_b64 exec, -1
  s_mov_b32 m0, 114688
  s_nop 0
  buffer_load_dwordx4 v8, s[28:31], m0 offen offset:0 sc1 lds
  buffer_load_dwordx4 v8, s[28:31], m0 offen offset:1024 sc1 lds
  buffer_load_dwordx4 v8, s[28:31], m0 offen offset:2048 sc1 lds
  buffer_load_dwordx4 v8, s[28:31], m0 offen offset:3072 sc1 lds
  s_waitcnt vmcnt(8)
  s_mov_b32 m0, 118784
  s_nop 0
  buffer_load_dwordx4 v8, s[28:31], m0 offen offset:0 sc1 lds
  buffer_load_dwordx4 v8, s[28:31], m0 offen offset:1024 sc1 lds
  buffer_load_dwordx4 v8, s[28:31], m0 offen offset:2048 sc1 lds
  buffer_load_dwordx4 v8, s[28:31], m0 offen offset:3072 sc1 lds
  s_waitcnt vmcnt(8)
  s_mov_b32 m0, 122880
  s_nop 0
  buffer_load_dwordx4 v8, s[28:31], m0 offen offset:0 sc1 lds
  buffer_load_dwordx4 v8, s[28:31], m0 offen offset:1024 sc1 lds
  buffer_load_dwordx4 v8, s[28:31], m0 offen offset:2048 sc1 lds
  buffer_load_dwordx4 v8, s[28:31], m0 offen offset:3072 sc1 lds
  s_waitcnt vmcnt(8)
  s_mov_b32 m0, 126976
  s_nop 0
  buffer_load_dwordx4 v8, s[28:31], m0 offen offset:0 sc1 lds
  buffer_load_dwordx4 v8, s[28:31], m0 offen offset:1024 sc1 lds
  buffer_load_dwordx4 v8, s[28:31], m0 offen offset:2048 sc1 lds
  buffer_load_dwordx4 v8, s[28:31], m0 offen offset:3072 sc1 lds
  s_waitcnt vmcnt(8)
  s_mov_b32 m0, 131072
  s_nop 0
  buffer_load_dwordx4 v8, s[28:31], m0 offen offset:0 sc1 lds
  buffer_load_dwordx4 v8, s[28:31], m0 offen offset:1024 sc1 lds
  buffer_load_dwordx4 v8, s[28:31], m0 offen offset:2048 sc1 lds
  buffer_load_dwordx4 v8, s[28:31], m0 offen offset:3072 sc1 lds
  s_waitcnt vmcnt(8)
  v_mov_b32 v127, 26
  s_mov_b64 exec, 1
  ds_write_b32 v125, v127 offset:56
  s_mov_b64 exec, -1
  s_mov_b32 m0, 135168
  s_nop 0
  buffer_load_dwordx4 v8, s[28:31], m0 offen offset:0 sc1 lds
  buffer_load_dwordx4 v8, s[28:31], m0 offen offset:1024 sc1 lds
  buffer_load_dwordx4 v8, s[28:31], m0 offen offset:2048 sc1 lds
  buffer_load_dwordx4 v8, s[28:31], m0 offen offset:3072 sc1 lds
  s_waitcnt vmcnt(8)
  s_mov_b32 m0, 139264
  s_nop 0
  buffer_load_dwordx4 v8, s[28:31], m0 offen offset:0 sc1 lds
  buffer_load_dwordx4 v8, s[28:31], m0 offen offset:1024 sc1 lds
  buffer_load_dwordx4 v8, s[28:31], m0 offen offset:2048 sc1 lds
  buffer_load_dwordx4 v8, s[28:31], m0 offen offset:3072 sc1 lds
  s_waitcnt vmcnt(8)
  s_mov_b32 m0, 143360
  s_nop 0
  buffer_load_dwordx4 v8, s[28:31], m0 offen offset:0 sc1 lds
  buffer_load_dwordx4 v8, s[28:31], m0 offen offset:1024 sc1 lds
  buffer_load_dwordx4 v8, s[28:31], m0 offen offset:2048 sc1 lds
  buffer_load_dwordx4 v8, s[28:31], m0 offen offset:3072 sc1 lds
  s_waitcnt vmcnt(8)
  s_mov_b32 m0, 147456
  s_nop 0
  buffer_load_dwordx4 v8, s[28:31], m0 offen offset:0 sc1 lds
  buffer_load_dwordx4 v8, s[28:31], m0 offen offset:1024 sc1 lds
  buffer_load_dwordx4 v8, s[28:31], m0 offen offset:2048 sc1 lds
  buffer_load_dwordx4 v8, s[28:31], m0 offen offset:3072 sc1 lds
  s_waitcnt vmcnt(0)
  v_mov_b32 v127, 32
  s_mov_b64 exec, 1
  ds_write_b32 v125, v127 offset:56
  s_mov_b64 exec, -1
LW_54:
  ds_read_b32 v127, v125 offset:68
  s_waitcnt lgkmcnt(0)
  v_readfirstlane_b32 s60, v127
  s_cmp_ge_u32 s60, 8
  s_cbranch_scc1 LW_54_d
  s_sleep 32
  s_branch LW_54
LW_54_d:
  s_add_u32 s52, s4, 335872
  s_addc_u32 s53, s5, 0
  s_mov_b32 s54, 32768
  s_mov_b32 s55, 0x20000
  s_mul_i32 s21, s3, 36
  s_lshl_b32 s22, s20, 3
  s_add_u32 s21, s21, s22
  v_mul_u32_u24 v10, 7, v2
  v_add_u32 v10, s21, v10
  v_lshrrev_b32 v10, 5, v10
  v_lshlrev_b32 v10, 2, v10
  s_lshl_b32 s21, s2, 7
  s_mov_b32 exec_lo, 3
  s_mov_b32 exec_hi, 0
  s_mov_b32 s62, 0
GP_55:
  buffer_load_dword v127, v10, s[52:55], s21 offen offset:0 sc1
  s_add_u32 s62, s62, 1
  s_waitcnt vmcnt(0)
  v_cmp_ne_u32 vcc, s61, v127
  s_cmp_eq_u64 vcc, 0
  s_cbranch_scc1 GP_55_d
  s_mov_b64 exec, vcc
  s_cmp_ge_u32 s62, 32768
  s_cbranch_scc1 GP_55_d
  s_sleep 8
  s_branch GP_55
GP_55_d:
  s_mov_b64 exec, -1
  s_add_u32 s52, s4, 294912
  s_addc_u32 s53, s5, 0
  s_mov_b32 s54, 4096
  s_mov_b32 s55, 0x20000
  s_lshl_b32 s21, s16, 7
  s_getreg_b32 s22, hwreg(HW_REG_XCC_ID)
  s_mov_b64 exec, 0xff
  buffer_load_dword v10, v8, s[52:55], s21 offen sc1
  s_waitcnt vmcnt(0)
  v_cmp_ne_u32 vcc, s22, v10
  s_mov_b64 exec, -1
  s_cmp_eq_u64 vcc, 0
  s_cselect_b32 s21, 2, 1
  v_mov_b32 v127, s21
  s_mov_b64 exec, 1
  ds_write_b32 v125, v127 offset:112
  s_mov_b64 exec, -1
  s_mov_b32 m0, 18432
  s_add_u32 s22, s17, 4
L_WO0:
  s_and_b32 s21, s22, 7
  s_mul_i32 s21, s21, 82944
  s_add_u32 s22, s22, 1
  buffer_load_dwordx4 v20, s[40:43], s21 offen offset:0 lds
  buffer_load_dwordx4 v21, s[40:43], s21 offen offset:1024 lds
  buffer_load_dwordx4 v22, s[40:43], s21 offen offset:2048 lds
  buffer_load_dwordx4 v23, s[40:43], s21 offen offset:3072 lds
  s_add_u32 m0, m0, 4096
  s_nop 0
  buffer_load_dwordx4 v24, s[40:43], s21 offen offset:0 lds
  buffer_load_dwordx4 v25, s[40:43], s21 offen offset:1024 lds
  buffer_load_dwordx4 v26, s[40:43], s21 offen offset:2048 lds
  buffer_load_dwordx4 v27, s[40:43], s21 offen offset:3072 lds
  s_add_u32 m0, m0, 4096
  s_nop 0
  buffer_load_dwordx4 v28, s[40:43], s21 offen offset:0 lds
  s_add_u32 m0, m0, 1024
  s_waitcnt vmcnt(9)
  s_cmp_lt_u32 m0, 46080
  s_cbranch_scc1 L_WO0
  v_mul_u32_u24 v10, 1152, v2
  s_add_u32 s21, s17, 2
  s_and_b32 s21, s21, 7
  s_mul_i32 s21, s21, 82944
  buffer_load_dword v12, v10, s[40:43], s21 offen
  buffer_load_dword v13, v10, s[40:43], s21 offen offset:128
  s_add_u32 s21, s21, 9216
  buffer_load_dword v12, v10, s[40:43], s21 offen
  buffer_load_dword v13, v10, s[40:43], s21 offen offset:128
  s_add_u32 s21, s21, 9216
  s_add_u32 s21, s17, 3
  s_and_b32 s21, s21, 7
  s_mul_i32 s21, s21, 82944
  buffer_load_dword v12, v10, s[40:43], s21 offen
  buffer_load_dword v13, v10, s[40:43], s21 offen offset:128
  s_add_u32 s21, s21, 9216
  buffer_load_dword v12, v10, s[40:43], s21 offen
  buffer_load_dword v13, v10, s[40:43], s21 offen offset:128
  s_add_u32 s21, s21, 9216
LW_56:
  ds_read_b32 v127, v125 offset:72
  s_waitcnt lgkmcnt(0)
  v_readfirstlane_b32 s60, v127
  s_cmp_ge_u32 s60, 8
  s_cbranch_scc1 LW_56_d
  s_sleep 32
  s_branch LW_56
LW_56_d:
  s_mov_b32 m0, 46080
  s_add_u32 s22, s17, 7
L_WO1:
  s_and_b32 s21, s22, 7
  s_mul_i32 s21, s21, 82944
  s_add_u32 s22, s22, 1
  buffer_load_dwordx4 v20, s[40:43], s21 offen offset:0 lds
  buffer_load_dwordx4 v21, s[40:43], s21 offen offset:1024 lds
  buffer_load_dwordx4 v22, s[40:43], s21 offen offset:2048 lds
  buffer_load_dwordx4 v23, s[40:43], s21 offen offset:3072 lds
  s_add_u32 m0, m0, 4096
  s_nop 0
  buffer_load_dwordx4 v24, s[40:43], s21 offen offset:0 lds
  buffer_load_dwordx4 v25, s[40:43], s21 offen offset:1024 lds
  buffer_load_dwordx4 v26, s[40:43], s21 offen offset:2048 lds
  buffer_load_dwordx4 v27, s[40:43], s21 offen offset:3072 lds
  s_add_u32 m0, m0, 4096
  s_nop 0
  buffer_load_dwordx4 v28, s[40:43], s21 offen offset:0 lds
  s_add_u32 m0, m0, 1024
  s_waitcnt vmcnt(9)
  s_cmp_lt_u32 m0, 73728
  s_cbranch_scc1 L_WO1
  buffer_load_dwordx4 v30, s[40:43], 0 offen offset:0 lds
  buffer_load_dwordx4 v31, s[40:43], 0 offen offset:1024 lds
  buffer_load_dwordx4 v32, s[40:43], 0 offen offset:2048 lds
  buffer_load_dwordx4 v33, s[40:43], 0 offen offset:3072 lds
  s_add_u32 m0, m0, 4096
  s_nop 0
  buffer_load_dwordx4 v34, s[40:43], 0 offen offset:0 lds
  buffer_load_dwordx4 v35, s[40:43], 0 offen offset:1024 lds
  buffer_load_dwordx4 v36, s[40:43], 0 offen offset:2048 lds
  buffer_load_dwordx4 v37, s[40:43], 0 offen offset:3072 lds
  s_add_u32 m0, m0, 4096
  s_nop 0
  buffer_load_dwordx4 v38, s[40:43], 0 offen offset:0 lds
LW_57:
  ds_read_b32 v127, v125 offset:96
  s_waitcnt lgkmcnt(0)
  v_readfirstlane_b32 s60, v127
  s_cmp_ge_u32 s60, 4
  s_cbranch_scc1 LW_57_d
  s_sleep 8
  s_branch LW_57
LW_57_d:
  s_mov_b32 m0, 0
  s_add_u32 s22, s17, 2
L_WO2:
  s_and_b32 s21, s22, 7
  s_mul_i32 s21, s21, 82944
  s_add_u32 s22, s22, 1
  buffer_load_dwordx4 v20, s[40:43], s21 offen offset:0 lds
  buffer_load_dwordx4 v21, s[40:43], s21 offen offset:1024 lds
  buffer_load_dwordx4 v22, s[40:43], s21 offen offset:2048 lds
  buffer_load_dwordx4 v23, s[40:43], s21 offen offset:3072 lds
  s_add_u32 m0, m0, 4096
  s_nop 0
  buffer_load_dwordx4 v24, s[40:43], s21 offen offset:0 lds
  buffer_load_dwordx4 v25, s[40:43], s21 offen offset:1024 lds
  buffer_load_dwordx4 v26, s[40:43], s21 offen offset:2048 lds
  buffer_load_dwordx4 v27, s[40:43], s21 offen offset:3072 lds
  s_add_u32 m0, m0, 4096
  s_nop 0
  buffer_load_dwordx4 v28, s[40:43], s21 offen offset:0 lds
  s_add_u32 m0, m0, 1024
  s_waitcnt vmcnt(9)
  s_cmp_lt_u32 m0, 18432
  s_cbranch_scc1 L_WO2
  s_waitcnt vmcnt(0)
  v_mov_b32 v127, 1
  s_mov_b64 exec, 1
  ds_write_b32 v125, v127 offset:76
  s_mov_b64 exec, -1
  s_endpgm
L_ATT:
  s_sub_u32 s18, s18, 8
  s_and_b32 s21, s18, 1
  s_lshl_b32 s39, s20, 1
  s_add_u32 s39, s39, s17
  s_sub_u32 s38, s39, 9
  s_cmp_ge_u32 s39, 9
  s_cselect_b32 s39, s38, s39
  v_bfe_u32 v101, v1, 1, 3
  v_xor_b32 v101, v101, v3
  v_lshlrev_b32 v96, 4, v101
  v_lshl_add_u32 v96, v1, 7, v96
  s_lshl_b32 s60, s21, 12
  s_add_u32 s60, s60, 23040
  v_add_u32 v96, s60, v96
  v_xor_b32 v97, 32, v96
  v_xor_b32 v98, 64, v96
  v_xor_b32 v99, 96, v96
  s_lshl_b32 s38, s39, 13
  v_add_u32 v96, s38, v96
  v_add_u32 v97, s38, v97
  v_add_u32 v98, s38, v98
  v_add_u32 v99, s38, v99
  v_and_b32 v101, 12, v2
  v_lshl_add_u32 v101, v3, 1, v101
  v_mul_u32_u24 v100, 144, v101
  v_bfe_u32 v101, v2, 4, 1
  v_bfe_u32 v102, v2, 1, 1
  v_lshl_add_u32 v101, v101, 1, v102
  v_and_b32 v102, 1, v2
  v_lshlrev_b32 v102, 4, v102
  v_lshl_add_u32 v102, v101, 3, v102
  v_cmp_eq_u32 vcc, 3, v101
  s_lshr_b32 s40, s18, 1
  s_mul_i32 s38, s40, 36
  v_cndmask_b32 v102, v102, 32, vcc
  s_and_b32 s41, s40, 1
  s_lshl_b32 s42, s41, 2
  s_sub_u32 s38, s38, s42
  s_add_u32 s38, s38, 96768
  v_add3_u32 v100, v100, v102, s38
  s_waitcnt lgkmcnt(0)
  s_mov_b32 s4, s6
  s_mov_b32 s5, s7
  s_load_dwordx2 s[10:11], s[0:1], 88
  s_barrier
  s_lshl_b32 s22, s16, 3
  s_add_u32 s22, s22, s17
  s_mul_i32 s23, s22, 9216
  s_add_u32 s23, s23, 655360
  s_add_u32 s24, s4, s23
  s_addc_u32 s25, s5, 0
  s_mov_b32 s26, 9216
  s_mov_b32 s27, 0x20000
  s_lshl_b32 s36, s21, 2
  s_add_u32 s36, s36, s40
  s_lshl_b32 s22, s22, 7
  s_lshl_b32 s23, s36, 4
  s_add_u32 s22, s22, s23
  s_add_u32 s22, s22, 262144
  s_add_u32 s28, s4, s22
  s_addc_u32 s29, s5, 0
  s_mov_b32 s30, 16
  s_mov_b32 s31, 0x20000
  s_lshl_b32 s36, s36, 10
  s_lshl_b32 s37, s40, 2
  s_lshl_b32 s23, s21, 9
  s_add_u32 s37, s37, s23
  s_add_u32 s37, s37, 8192
  s_lshl_b32 s22, s16, 1
  s_add_u32 s22, s22, s21
  s_mul_i32 s22, s22, 73728
  s_mul_i32 s23, s17, 144
  s_add_u32 s22, s22, s23
  s_lshl_b32 s23, s40, 5
  s_add_u32 s22, s22, s23
  s_add_u32 s22, s22, 1152
  s_waitcnt lgkmcnt(0)
  s_add_u32 s32, s10, s22
  s_addc_u32 s33, s11, 0
  s_mov_b32 s34, 71456
  s_mov_b32 s35, 0x20000
  v_and_b32 v103, 15, v2
  v_lshl_add_u32 v103, v103, 2, v125
  s_setprio 3
  v_lshlrev_b32 v4, 4, v2
  v_lshlrev_b32 v5, 2, v2
  v_lshlrev_b32 v6, 4, v1
  v_mul_u32_u24 v123, 304, v3
  v_add_u32 v6, v6, v123
  v_mov_b32 v123, 0x40000
  v_cmp_lt_u32 vcc, 18, v1
  v_mov_b32 v7, 0xdddddddd
  v_mov_b32 v113, 0x3f80
  v_cndmask_b32 v6, v6, v123, vcc
  v_mov_b32 v72, 0
  v_mov_b32 v73, 0
  v_mov_b32 v74, 0
  v_mov_b32 v75, 0
  v_mov_b32 v76, 0
  v_mov_b32 v77, 0
  v_mov_b32 v78, 0
  v_mov_b32 v79, 0
  v_mov_b32 v80, 0
  v_mov_b32 v81, 0
  v_mov_b32 v82, 0
  v_mov_b32 v83, 0
  v_mov_b32 v84, 0
  v_mov_b32 v85, 0
  v_mov_b32 v86, 0
  v_mov_b32 v87, 0
LW_58:
  ds_read_b32 v127, v125 offset:0
  s_waitcnt lgkmcnt(0)
  v_readfirstlane_b32 s60, v127
  s_cmp_ge_u32 s60, 8
  s_cbranch_scc1 LW_58_d
  s_sleep 1
  s_branch LW_58
LW_58_d:
  s_mov_b32 s47, 0
  ds_read_b128 v[24:27], v96
  ds_read_b64_tr_b16 v[28:29], v100 offset:0
  ds_read_b64_tr_b16 v[30:31], v100 offset:144
  ds_read_b128 v[32:35], v97
  ds_read_b64_tr_b16 v[36:37], v100 offset:2304
  ds_read_b64_tr_b16 v[38:39], v100 offset:2448
  ds_read_b128 v[40:43], v98
  ds_read_b64_tr_b16 v[44:45], v100 offset:4608
  ds_read_b64_tr_b16 v[46:47], v100 offset:4752
  ds_read_b128 v[48:51], v99
  ds_read_b64_tr_b16 v[52:53], v100 offset:6912
  ds_read_b64_tr_b16 v[54:55], v100 offset:7056
  s_add_u32 s39, s39, 1
  s_cmp_eq_u32 s39, 9
  s_cselect_b32 s39, 0, s39
  s_movk_i32 s38, 8192
  s_cselect_b32 s38, 4294901760, s38
  v_add_u32 v96, s38, v96
  v_add_u32 v97, s38, v97
  v_add_u32 v98, s38, v98
  v_add_u32 v99, s38, v99
  s_bitcmp1_b32 s47, 1
  s_cbranch_scc0 L_QS1
L_QR1:
  ds_read_b128 v[56:59], v96
  ds_read_b64_tr_b16 v[60:61], v100 offset:9216
  ds_read_b64_tr_b16 v[62:63], v100 offset:9360
  s_waitcnt lgkmcnt(12)
  v_mfma_f32_32x32x16_bf16 v[8:23], v[28:31], v[24:27], 0
  ds_read_b128 v[24:27], v97
  ds_read_b64_tr_b16 v[28:29], v100 offset:11520
  ds_read_b64_tr_b16 v[30:31], v100 offset:11664
  s_waitcnt lgkmcnt(12)
  v_mfma_f32_32x32x16_bf16 v[8:23], v[36:39], v[32:35], v[8:23]
  ds_read_b128 v[32:35], v98
  ds_read_b64_tr_b16 v[36:37], v100 offset:13824
  ds_read_b64_tr_b16 v[38:39], v100 offset:13968
  s_waitcnt lgkmcnt(12)
  v_mfma_f32_32x32x16_bf16 v[8:23], v[44:47], v[40:43], v[8:23]
  ds_read_b128 v[40:43], v99
  ds_read_b64_tr_b16 v[44:45], v100 offset:16128
  ds_read_b64_tr_b16 v[46:47], v100 offset:16272
  s_add_u32 s39, s39, 1
  s_cmp_eq_u32 s39, 9
  s_cselect_b32 s39, 0, s39
  s_movk_i32 s38, 8192
  s_cselect_b32 s38, 4294901760, s38
  v_add_u32 v96, s38, v96
  v_add_u32 v97, s38, v97
  v_add_u32 v98, s38, v98
  v_add_u32 v99, s38, v99
  s_waitcnt lgkmcnt(12)
  v_mfma_f32_32x32x16_bf16 v[8:23], v[52:55], v[48:51], v[8:23]
  s_mov_b64 exec, 1
  ds_add_u32 v125, v126 offset:36
  s_mov_b64 exec, -1
  s_bitcmp1_b32 s47, 2
  s_cbranch_scc0 L_QS2
L_QR2:
  ds_read_b128 v[48:51], v96
  ds_read_b64_tr_b16 v[52:53], v100 offset:18432
  ds_read_b64_tr_b16 v[54:55], v100 offset:18576
  s_waitcnt lgkmcnt(12)
  v_mfma_f32_32x32x16_bf16 v[8:23], v[60:63], v[56:59], v[8:23]
  ds_read_b128 v[56:59], v97
  ds_read_b64_tr_b16 v[60:61], v100 offset:20736
  ds_read_b64_tr_b16 v[62:63], v100 offset:20880
  s_waitcnt lgkmcnt(12)
  v_mfma_f32_32x32x16_bf16 v[8:23], v[28:31], v[24:27], v[8:23]
  ds_read_b128 v[24:27], v98
  ds_read_b64_tr_b16 v[28:29], v100 offset:23040
  ds_read_b64_tr_b16 v[30:31], v100 offset:23184
  s_waitcnt lgkmcnt(12)
  v_mfma_f32_32x32x16_bf16 v[8:23], v[36:39], v[32:35], v[8:23]
  ds_read_b128 v[32:35], v99
  ds_read_b64_tr_b16 v[36:37], v100 offset:25344
  ds_read_b64_tr_b16 v[38:39], v100 offset:25488
  s_add_u32 s39, s39, 1
  s_cmp_eq_u32 s39, 9
  s_cselect_b32 s39, 0, s39
  s_movk_i32 s38, 8192
  s_cselect_b32 s38, 4294901760, s38
  v_add_u32 v96, s38, v96
  v_add_u32 v97, s38, v97
  v_add_u32 v98, s38, v98
  v_add_u32 v99, s38, v99
  s_waitcnt lgkmcnt(12)
  v_mfma_f32_32x32x16_bf16 v[8:23], v[44:47], v[40:43], v[8:23]
  s_mov_b64 exec, 1
  ds_add_u32 v125, v126 offset:40
  s_mov_b64 exec, -1
  s_bitcmp1_b32 s47, 3
  s_cbranch_scc0 L_QS3
L_QR3:
  ds_read_b128 v[40:43], v96
  ds_read_b64_tr_b16 v[44:45], v100 offset:27648
  ds_read_b64_tr_b16 v[46:47], v100 offset:27792
  s_waitcnt lgkmcnt(12)
  v_mfma_f32_32x32x16_bf16 v[8:23], v[52:55], v[48:51], v[8:23]
  ds_read_b128 v[48:51], v97
  ds_read_b64_tr_b16 v[52:53], v100 offset:29952
  ds_read_b64_tr_b16 v[54:55], v100 offset:30096
  s_waitcnt lgkmcnt(12)
  v_mfma_f32_32x32x16_bf16 v[8:23], v[60:63], v[56:59], v[8:23]
  ds_read_b128 v[56:59], v98
  ds_read_b64_tr_b16 v[60:61], v100 offset:32256
  ds_read_b64_tr_b16 v[62:63], v100 offset:32400
  s_waitcnt lgkmcnt(12)
  v_mfma_f32_32x32x16_bf16 v[8:23], v[28:31], v[24:27], v[8:23]
  ds_read_b128 v[24:27], v99
  ds_read_b64_tr_b16 v[28:29], v100 offset:34560
  ds_read_b64_tr_b16 v[30:31], v100 offset:34704
  s_add_u32 s39, s39, 1
  s_cmp_eq_u32 s39, 9
  s_cselect_b32 s39, 0, s39
  s_movk_i32 s38, 8192
  s_cselect_b32 s38, 4294901760, s38
  v_add_u32 v96, s38, v96
  v_add_u32 v97, s38, v97
  v_add_u32 v98, s38, v98
  v_add_u32 v99, s38, v99
  s_waitcnt lgkmcnt(12)
  v_mfma_f32_32x32x16_bf16 v[8:23], v[36:39], v[32:35], v[8:23]
  s_bitcmp1_b32 s47, 4
  s_cbranch_scc0 L_QS4
L_QR4:
  ds_read_b128 v[32:35], v96
  ds_read_b64_tr_b16 v[36:37], v100 offset:36864
  ds_read_b64_tr_b16 v[38:39], v100 offset:37008
  s_waitcnt lgkmcnt(12)
  v_mfma_f32_32x32x16_bf16 v[8:23], v[44:47], v[40:43], v[8:23]
  ds_read_b128 v[40:43], v97
  ds_read_b64_tr_b16 v[44:45], v100 offset:39168
  ds_read_b64_tr_b16 v[46:47], v100 offset:39312
  s_waitcnt lgkmcnt(12)
  v_mfma_f32_32x32x16_bf16 v[8:23], v[52:55], v[48:51], v[8:23]
  ds_read_b128 v[48:51], v98
  ds_read_b64_tr_b16 v[52:53], v100 offset:41472
  ds_read_b64_tr_b16 v[54:55], v100 offset:41616
  s_waitcnt lgkmcnt(12)
  v_mfma_f32_32x32x16_bf16 v[8:23], v[60:63], v[56:59], v[8:23]
  ds_read_b128 v[56:59], v99
  ds_read_b64_tr_b16 v[60:61], v100 offset:43776
  ds_read_b64_tr_b16 v[62:63], v100 offset:43920
  s_add_u32 s39, s39, 1
  s_cmp_eq_u32 s39, 9
  s_cselect_b32 s39, 0, s39
  s_movk_i32 s38, 8192
  s_cselect_b32 s38, 4294901760, s38
  v_add_u32 v96, s38, v96
  v_add_u32 v97, s38, v97
  v_add_u32 v98, s38, v98
  v_add_u32 v99, s38, v99
  s_waitcnt lgkmcnt(12)
  v_mfma_f32_32x32x16_bf16 v[8:23], v[28:31], v[24:27], v[8:23]
  s_bitcmp1_b32 s47, 5
  s_cbranch_scc0 L_QS5
L_QR5:
  ds_read_b128 v[24:27], v96
  ds_read_b64_tr_b16 v[28:29], v100 offset:46080
  ds_read_b64_tr_b16 v[30:31], v100 offset:46224
  s_waitcnt lgkmcnt(12)
  v_mfma_f32_32x32x16_bf16 v[8:23], v[36:39], v[32:35], v[8:23]
  ds_read_b128 v[32:35], v97
  ds_read_b64_tr_b16 v[36:37], v100 offset:48384
  ds_read_b64_tr_b16 v[38:39], v100 offset:48528
  s_waitcnt lgkmcnt(12)
  v_mfma_f32_32x32x16_bf16 v[8:23], v[44:47], v[40:43], v[8:23]
  ds_read_b128 v[40:43], v98
  ds_read_b64_tr_b16 v[44:45], v100 offset:50688
  ds_read_b64_tr_b16 v[46:47], v100 offset:50832
  s_waitcnt lgkmcnt(12)
  v_mfma_f32_32x32x16_bf16 v[8:23], v[52:55], v[48:51], v[8:23]
  ds_read_b128 v[48:51], v99
  ds_read_b64_tr_b16 v[52:53], v100 offset:52992
  ds_read_b64_tr_b16 v[54:55], v100 offset:53136
  s_add_u32 s39, s39, 1
  s_cmp_eq_u32 s39, 9
  s_cselect_b32 s39, 0, s39
  s_movk_i32 s38, 8192
  s_cselect_b32 s38, 4294901760, s38
  v_add_u32 v96, s38, v96
  v_add_u32 v97, s38, v97
  v_add_u32 v98, s38, v98
  v_add_u32 v99, s38, v99
  s_waitcnt lgkmcnt(12)
  v_mfma_f32_32x32x16_bf16 v[8:23], v[60:63], v[56:59], v[8:23]
  s_bitcmp1_b32 s47, 6
  s_cbranch_scc0 L_QS6
L_QR6:
  ds_read_b128 v[56:59], v96
  ds_read_b64_tr_b16 v[60:61], v100 offset:55296
  ds_read_b64_tr_b16 v[62:63], v100 offset:55440
  s_waitcnt lgkmcnt(12)
  v_mfma_f32_32x32x16_bf16 v[8:23], v[28:31], v[24:27], v[8:23]
  ds_read_b128 v[24:27], v97
  ds_read_b64_tr_b16 v[28:29], v100 offset:57600
  ds_read_b64_tr_b16 v[30:31], v100 offset:57744
  s_waitcnt lgkmcnt(12)
  v_mfma_f32_32x32x16_bf16 v[8:23], v[36:39], v[32:35], v[8:23]
  ds_read_b128 v[32:35], v98
  ds_read_b64_tr_b16 v[36:37], v100 offset:59904
  ds_read_b64_tr_b16 v[38:39], v100 offset:60048
  s_waitcnt lgkmcnt(12)
  v_mfma_f32_32x32x16_bf16 v[8:23], v[44:47], v[40:43], v[8:23]
  ds_read_b128 v[40:43], v99
  ds_read_b64_tr_b16 v[44:45], v100 offset:62208
  ds_read_b64_tr_b16 v[46:47], v100 offset:62352
  s_add_u32 s39, s39, 1
  s_cmp_eq_u32 s39, 9
  s_cselect_b32 s39, 0, s39
  s_movk_i32 s38, 8192
  s_cselect_b32 s38, 4294901760, s38
  v_add_u32 v96, s38, v96
  v_add_u32 v97, s38, v97
  v_add_u32 v98, s38, v98
  v_add_u32 v99, s38, v99
  s_waitcnt lgkmcnt(12)
  v_mfma_f32_32x32x16_bf16 v[8:23], v[52:55], v[48:51], v[8:23]
  s_bitcmp1_b32 s47, 7
  s_cbranch_scc0 L_QS7
L_QR7:
  ds_read_b128 v[48:51], v96
  ds_read_b64_tr_b16 v[52:53], v100 offset:0
  ds_read_b64_tr_b16 v[54:55], v100 offset:144
  s_waitcnt lgkmcnt(12)
  v_mfma_f32_32x32x16_bf16 v[8:23], v[60:63], v[56:59], v[8:23]
  ds_read_b128 v[56:59], v97
  ds_read_b64_tr_b16 v[60:61], v100 offset:2304
  ds_read_b64_tr_b16 v[62:63], v100 offset:2448
  s_waitcnt lgkmcnt(12)
  v_mfma_f32_32x32x16_bf16 v[8:23], v[28:31], v[24:27], v[8:23]
  ds_read_b128 v[24:27], v98
  ds_read_b64_tr_b16 v[28:29], v100 offset:4608
  ds_read_b64_tr_b16 v[30:31], v100 offset:4752
  s_waitcnt lgkmcnt(12)
  v_mfma_f32_32x32x16_bf16 v[8:23], v[36:39], v[32:35], v[8:23]
  ds_read_b128 v[32:35], v99
  ds_read_b64_tr_b16 v[36:37], v100 offset:6912
  ds_read_b64_tr_b16 v[38:39], v100 offset:7056
  s_add_u32 s39, s39, 1
  s_cmp_eq_u32 s39, 9
  s_cselect_b32 s39, 0, s39
  s_movk_i32 s38, 8192
  s_cselect_b32 s38, 4294901760, s38
  v_add_u32 v96, s38, v96
  v_add_u32 v97, s38, v97
  v_add_u32 v98, s38, v98
  v_add_u32 v99, s38, v99
  s_waitcnt lgkmcnt(12)
  v_mfma_f32_32x32x16_bf16 v[8:23], v[44:47], v[40:43], v[8:23]
  s_bitcmp1_b32 s47, 8
  s_cbranch_scc0 L_QS8
L_QR8:
  ds_read_b128 v[40:43], v96
  ds_read_b64_tr_b16 v[44:45], v100 offset:9216
  ds_read_b64_tr_b16 v[46:47], v100 offset:9360
  s_waitcnt lgkmcnt(12)
  v_mfma_f32_32x32x16_bf16 v[8:23], v[52:55], v[48:51], v[8:23]
  ds_read_b128 v[48:51], v97
  ds_read_b64_tr_b16 v[52:53], v100 offset:11520
  ds_read_b64_tr_b16 v[54:55], v100 offset:11664
  s_waitcnt lgkmcnt(12)
  v_mfma_f32_32x32x16_bf16 v[8:23], v[60:63], v[56:59], v[8:23]
  ds_read_b128 v[56:59], v98
  ds_read_b64_tr_b16 v[60:61], v100 offset:13824
  ds_read_b64_tr_b16 v[62:63], v100 offset:13968
  s_waitcnt lgkmcnt(12)
  v_mfma_f32_32x32x16_bf16 v[8:23], v[28:31], v[24:27], v[8:23]
  ds_read_b128 v[24:27], v99
  ds_read_b64_tr_b16 v[28:29], v100 offset:16128
  ds_read_b64_tr_b16 v[30:31], v100 offset:16272
  s_waitcnt lgkmcnt(12)
  v_mfma_f32_32x32x16_bf16 v[8:23], v[36:39], v[32:35], v[8:23]
  s_waitcnt lgkmcnt(9)
  v_mfma_f32_32x32x16_bf16 v[8:23], v[44:47], v[40:43], v[8:23]
  s_waitcnt lgkmcnt(6)
  v_mfma_f32_32x32x16_bf16 v[8:23], v[52:55], v[48:51], v[8:23]
  s_waitcnt lgkmcnt(3)
  v_mfma_f32_32x32x16_bf16 v[8:23], v[60:63], v[56:59], v[8:23]
  s_waitcnt lgkmcnt(0)
  v_mfma_f32_32x32x16_bf16 v[8:23], v[28:31], v[24:27], v[8:23]
  s_mov_b64 exec, 1
  ds_add_u32 v125, v126 offset:48
  s_mov_b64 exec, -1
  s_mov_b64 exec, 1
  ds_add_u32 v125, v126 offset:120
  s_mov_b64 exec, -1
  s_waitcnt vmcnt(0)
  s_mov_b32 s38, 1051597459
  s_nop 2
  s_cmp_eq_u32 s41, 1
  s_cbranch_scc1 L_QODD
  v_mul_f32 v8, s38, v8
  v_mul_f32 v9, s38, v9
  v_mul_f32 v10, s38, v10
  v_mul_f32 v11, s38, v11
  v_mul_f32 v12, s38, v12
  v_mul_f32 v13, s38, v13
  v_mul_f32 v14, s38, v14
  v_mul_f32 v15, s38, v15
  v_mul_f32 v20, s38, v20
  v_mul_f32 v21, s38, v21
  v_cvt_pk_bf16_f32 v116, v8, v9
  v_cvt_pk_bf16_f32 v117, v10, v11
  v_cvt_pk_bf16_f32 v118, v12, v13
  v_cvt_pk_bf16_f32 v119, v14, v15
  v_cvt_pk_bf16_f32 v114, v20, v21
  s_branch L_QDONE
L_QODD:
  v_mul_f32 v10, s38, v10
  v_mul_f32 v11, s38, v11
  v_mul_f32 v12, s38, v12
  v_mul_f32 v13, s38, v13
  v_mul_f32 v14, s38, v14
  v_mul_f32 v15, s38, v15
  v_mul_f32 v16, s38, v16
  v_mul_f32 v17, s38, v17
  v_mul_f32 v22, s38, v22
  v_mul_f32 v23, s38, v23
  v_cvt_pk_bf16_f32 v116, v10, v11
  v_cvt_pk_bf16_f32 v117, v12, v13
  v_cvt_pk_bf16_f32 v118, v14, v15
  v_cvt_pk_bf16_f32 v119, v16, v17
  v_cvt_pk_bf16_f32 v114, v22, v23
L_QDONE:
  v_cmp_eq_u32 vcc, 0, v3
  v_mov_b32 v123, 0
  s_nop 0
  v_cndmask_b32 v124, 0, v114, vcc
  v_dot2_f32_bf16 v123, v116, v116, v123
  v_dot2_f32_bf16 v123, v117, v117, v123
  v_dot2_f32_bf16 v123, v118, v118, v123
  v_dot2_f32_bf16 v123, v119, v119, v123
  v_dot2_f32_bf16 v123, v124, v124, v123
  s_nop 2
  v_mov_b32 v124, v123
  s_nop 1
  v_permlane32_swap_b32 v123, v124
  s_nop 1
  v_add_f32 v123, v123, v124
LW_59:
  ds_read_b32 v127, v125 offset:56
  s_waitcnt lgkmcnt(0)
  v_readfirstlane_b32 s43, v127
  s_cmp_ge_u32 s43, 2
  s_cbranch_scc1 LW_59_d
  s_sleep 1
  s_branch LW_59
LW_59_d:
  ds_read_b32 v122, v125 offset:60
  ds_read_b32 v112, v5 offset:2048
  ds_read_b128 v[104:107], v4
  ds_read_b128 v[108:111], v4 offset:1024
  ds_read_b128 v[88:91], v6 offset:2304
  ds_read_b128 v[92:95], v6 offset:2912
  ds_read_b128 v[96:99], v6 offset:3520
  ds_read_b128 v[100:103], v6 offset:4128
  s_waitcnt lgkmcnt(4)
  v_mfma_f32_32x32x16_bf16 v[8:23], v[104:107], v[116:119], 0
  v_mfma_f32_32x32x16_bf16 v[24:39], v[108:111], v[116:119], 0
  ds_read_b128 v[104:107], v4 offset:4736
  ds_read_b128 v[108:111], v4 offset:5760
  v_mul_f32 v123, v122, v123
  v_sqrt_f32 v123, v123
  s_mov_b32 s38, 1107296256
  v_mul_f32 v123, 1065437102, v123
  v_cmp_nge_f32 vcc, s38, v123
  v_cvt_pk_bf16_f32 v115, -v123, 0
  s_cmp_lg_u64 vcc, 0
  s_cbranch_scc1 L_SLOW
  v_mfma_f32_32x32x4_2b_bf16 v[8:39], v[112:113], v[114:115], v[8:39]
  ds_read_b32 v112, v5 offset:6784
  s_setprio 2
  s_cmp_ge_u32 s43, 4
  s_cbranch_scc1 KC_60
LW_61:
  ds_read_b32 v127, v125 offset:56
  s_waitcnt lgkmcnt(0)
  v_readfirstlane_b32 s43, v127
  s_cmp_ge_u32 s43, 4
  s_cbranch_scc1 LW_61_d
  s_sleep 1
  s_branch LW_61
LW_61_d:
KC_60:
  s_nop 15
  s_waitcnt lgkmcnt(0)
  s_cmp_lt_u32 s18, 4
  s_cbranch_scc1 TL_62
  s_setprio 1
TL_62:
  v_exp_f32 v8, v8
  v_exp_f32 v9, v9
  v_exp_f32 v10, v10
  v_exp_f32 v11, v11
  v_exp_f32 v12, v12
  v_exp_f32 v13, v13
  v_mfma_f32_32x32x4_2b_bf16 v[40:71], v[112:113], v[114:115], 0
  ds_read_b32 v112, v5 offset:11520
  v_exp_f32 v14, v14
  v_exp_f32 v15, v15
  v_exp_f32 v16, v16
  v_exp_f32 v17, v17
  v_exp_f32 v18, v18
  v_exp_f32 v19, v19
  v_exp_f32 v20, v20
  v_exp_f32 v21, v21
  v_smfmac_f32_32x32x32_bf16 v[72:87], v[88:91], v[8:15], v7
  ds_read_b128 v[88:91], v6 offset:7040
  v_exp_f32 v22, v22
  v_exp_f32 v23, v23
  v_exp_f32 v24, v24
  v_exp_f32 v25, v25
  v_smfmac_f32_32x32x32_bf16 v[72:87], v[92:95], v[16:23], v7
  ds_read_b128 v[92:95], v6 offset:7648
  v_exp_f32 v26, v26
  v_exp_f32 v27, v27
  v_exp_f32 v28, v28
  s_waitcnt lgkmcnt(4)
  v_exp_f32_e64 v29, v29
  v_mfma_f32_32x32x16_bf16 v[40:55], v[104:107], v[116:119], v[40:55]
  ds_read_b128 v[104:107], v4 offset:9472
  v_exp_f32 v30, v30
  v_exp_f32 v31, v31
  v_exp_f32 v32, v32
  v_exp_f32 v33, v33
  v_mfma_f32_32x32x16_bf16 v[56:71], v[108:111], v[116:119], v[56:71]
  ds_read_b128 v[108:111], v4 offset:10496
  v_exp_f32 v34, v34
  v_exp_f32 v35, v35
  v_exp_f32 v36, v36
  v_exp_f32 v37, v37
  v_smfmac_f32_32x32x32_bf16 v[72:87], v[96:99], v[24:31], v7
  ds_read_b128 v[96:99], v6 offset:8256
  v_exp_f32 v38, v38
  v_exp_f32 v39, v39
  v_exp_f32 v40, v40
  s_waitcnt lgkmcnt(3)
  v_exp_f32_e64 v41, v41
  v_smfmac_f32_32x32x32_bf16 v[72:87], v[100:103], v[32:39], v7
  ds_read_b128 v[100:103], v6 offset:8864
  v_exp_f32 v42, v42
  v_exp_f32 v43, v43
  v_exp_f32 v44, v44
  v_exp_f32 v45, v45
  v_mfma_f32_32x32x4_2b_bf16 v[8:39], v[112:113], v[114:115], 0
  ds_read_b32 v112, v5 offset:16256
  v_exp_f32 v46, v46
  v_exp_f32 v47, v47
  v_exp_f32 v48, v48
  v_exp_f32 v49, v49
  s_cmp_lt_u32 s18, 4
  s_cbranch_scc1 TG_63
  s_setprio 3
TG_63:
  v_exp_f32 v50, v50
  v_exp_f32 v51, v51
  v_exp_f32 v52, v52
  v_exp_f32 v53, v53
  v_smfmac_f32_32x32x32_bf16 v[72:87], v[88:91], v[40:47], v7
  ds_read_b128 v[88:91], v6 offset:11776
  v_exp_f32 v54, v54
  v_exp_f32 v55, v55
  v_exp_f32 v56, v56
  v_exp_f32 v57, v57
  v_smfmac_f32_32x32x32_bf16 v[72:87], v[92:95], v[48:55], v7
  ds_read_b128 v[92:95], v6 offset:12384
  v_exp_f32 v58, v58
  v_exp_f32 v59, v59
  v_exp_f32 v60, v60
  s_waitcnt lgkmcnt(4)
  v_exp_f32_e64 v61, v61
  v_mfma_f32_32x32x16_bf16 v[8:23], v[104:107], v[116:119], v[8:23]
  ds_read_b128 v[104:107], v4 offset:14208
  v_exp_f32 v62, v62
  v_exp_f32 v63, v63
  v_exp_f32 v64, v64
  v_exp_f32 v65, v65
  v_mfma_f32_32x32x16_bf16 v[24:39], v[108:111], v[116:119], v[24:39]
  ds_read_b128 v[108:111], v4 offset:15232
  v_exp_f32 v66, v66
  v_exp_f32 v67, v67
  v_exp_f32 v68, v68
  v_exp_f32 v69, v69
  v_smfmac_f32_32x32x32_bf16 v[72:87], v[96:99], v[56:63], v7
  ds_read_b128 v[96:99], v6 offset:12992
  v_exp_f32 v70, v70
  v_exp_f32 v71, v71
  s_cmp_ge_u32 s43, 6
  s_cbranch_scc1 KC_64
LW_65:
  ds_read_b32 v127, v125 offset:56
  s_waitcnt lgkmcnt(0)
  v_readfirstlane_b32 s43, v127
  s_cmp_ge_u32 s43, 6
  s_cbranch_scc1 LW_65_d
  s_sleep 1
  s_branch LW_65
LW_65_d:
KC_64:
  v_exp_f32 v8, v8
  s_waitcnt lgkmcnt(3)
  v_exp_f32_e64 v9, v9
  v_smfmac_f32_32x32x32_bf16 v[72:87], v[100:103], v[64:71], v7
  ds_read_b128 v[100:103], v6 offset:13600
  v_exp_f32 v10, v10
  v_exp_f32 v11, v11
  v_exp_f32 v12, v12
  v_exp_f32 v13, v13
  v_mfma_f32_32x32x4_2b_bf16 v[40:71], v[112:113], v[114:115], 0
  ds_read_b32 v112, v5 offset:20992
  v_exp_f32 v14, v14
  v_exp_f32 v15, v15
  v_exp_f32 v16, v16
  v_exp_f32 v17, v17
  v_exp_f32 v18, v18
  v_exp_f32 v19, v19
  v_exp_f32 v20, v20
  v_exp_f32 v21, v21
  v_smfmac_f32_32x32x32_bf16 v[72:87], v[88:91], v[8:15], v7
  ds_read_b128 v[88:91], v6 offset:16512
  v_exp_f32 v22, v22
  v_exp_f32 v23, v23
  v_exp_f32 v24, v24
  v_exp_f32 v25, v25
  v_smfmac_f32_32x32x32_bf16 v[72:87], v[92:95], v[16:23], v7
  ds_read_b128 v[92:95], v6 offset:17120
  v_exp_f32 v26, v26
  v_exp_f32 v27, v27
  v_exp_f32 v28, v28
  s_waitcnt lgkmcnt(4)
  v_exp_f32_e64 v29, v29
  v_mfma_f32_32x32x16_bf16 v[40:55], v[104:107], v[116:119], v[40:55]
  ds_read_b128 v[104:107], v4 offset:18944
  v_exp_f32 v30, v30
  v_exp_f32 v31, v31
  v_exp_f32 v32, v32
  v_exp_f32 v33, v33
  v_mfma_f32_32x32x16_bf16 v[56:71], v[108:111], v[116:119], v[56:71]
  ds_read_b128 v[108:111], v4 offset:19968
  v_exp_f32 v34, v34
  v_exp_f32 v35, v35
  v_exp_f32 v36, v36
  v_exp_f32 v37, v37
  v_smfmac_f32_32x32x32_bf16 v[72:87], v[96:99], v[24:31], v7
  ds_read_b128 v[96:99], v6 offset:17728
  v_exp_f32 v38, v38
  v_exp_f32 v39, v39
  v_exp_f32 v40, v40
  s_waitcnt lgkmcnt(3)
  v_exp_f32_e64 v41, v41
  v_smfmac_f32_32x32x32_bf16 v[72:87], v[100:103], v[32:39], v7
  ds_read_b128 v[100:103], v6 offset:18336
  v_exp_f32 v42, v42
  v_exp_f32 v43, v43
  v_exp_f32 v44, v44
  v_exp_f32 v45, v45
  v_mfma_f32_32x32x4_2b_bf16 v[8:39], v[112:113], v[114:115], 0
  ds_read_b32 v112, v5 offset:25728
  v_exp_f32 v46, v46
  v_exp_f32 v47, v47
  v_exp_f32 v48, v48
  v_exp_f32 v49, v49
  v_exp_f32 v50, v50
  v_exp_f32 v51, v51
  v_exp_f32 v52, v52
  v_exp_f32 v53, v53
  v_smfmac_f32_32x32x32_bf16 v[72:87], v[88:91], v[40:47], v7
  ds_read_b128 v[88:91], v6 offset:21248
  v_exp_f32 v54, v54
  v_exp_f32 v55, v55
  v_exp_f32 v56, v56
  v_exp_f32 v57, v57
  v_smfmac_f32_32x32x32_bf16 v[72:87], v[92:95], v[48:55], v7
  ds_read_b128 v[92:95], v6 offset:21856
  v_exp_f32 v58, v58
  v_exp_f32 v59, v59
  v_exp_f32 v60, v60
  s_waitcnt lgkmcnt(4)
  v_exp_f32_e64 v61, v61
  v_mfma_f32_32x32x16_bf16 v[8:23], v[104:107], v[116:119], v[8:23]
  ds_read_b128 v[104:107], v4 offset:23680
  v_exp_f32 v62, v62
  v_exp_f32 v63, v63
  v_exp_f32 v64, v64
  v_exp_f32 v65, v65
  v_mfma_f32_32x32x16_bf16 v[24:39], v[108:111], v[116:119], v[24:39]
  ds_read_b128 v[108:111], v4 offset:24704
  v_exp_f32 v66, v66
  v_exp_f32 v67, v67
  v_exp_f32 v68, v68
  v_exp_f32 v69, v69
  v_smfmac_f32_32x32x32_bf16 v[72:87], v[96:99], v[56:63], v7
  ds_read_b128 v[96:99], v6 offset:22464
  v_exp_f32 v70, v70
  v_exp_f32 v71, v71
  s_mov_b32 s44, 1
  s_mov_b32 s45, 10
.p2align 6
L_LOOP:
  v_add_u32 v4, 18944, v4
  v_add_u32 v5, 18944, v5
  v_add_u32 v6, 18944, v6
  s_cmp_ge_u32 s43, s45
  s_cbranch_scc1 KC_66
LW_67:
  ds_read_b32 v127, v125 offset:56
  s_waitcnt lgkmcnt(0)
  v_readfirstlane_b32 s43, v127
  s_cmp_ge_u32 s43, s45
  s_cbranch_scc1 LW_67_d
  s_sleep 1
  s_branch LW_67
LW_67_d:
KC_66:
  s_add_u32 s45, s45, 4
  s_min_u32 s45, s45, 32
  s_cmp_lt_u32 s18, 4
  s_cbranch_scc1 TL_68
  s_setprio 1
TL_68:
  s_cmp_lg_u32 s44, 3
  s_cbranch_scc1 L_P3
  s_mov_b64 exec, 1
  ds_add_u32 v125, v126 offset:68
  s_mov_b64 exec, -1
L_P3:
  s_cmp_lg_u32 s44, 4
  s_cbranch_scc1 L_P4
  s_mov_b64 exec, 1
  ds_add_u32 v125, v126 offset:84
  s_mov_b64 exec, -1
L_P4:
  s_cmp_lg_u32 s44, 5
  s_cbranch_scc1 L_P1
  s_mov_b64 exec, 1
  ds_add_u32 v125, v126 offset:72
  s_mov_b64 exec, -1
L_P1:
  s_cmp_lg_u32 s44, 7
  s_cbranch_scc1 L_P7
LW_69:
  ds_read_b32 v127, v125 offset:112
  s_waitcnt lgkmcnt(0)
  v_readfirstlane_b32 s46, v127
  s_cmp_ge_u32 s46, 1
  s_cbranch_scc1 LW_69_d
  s_sleep 1
  s_branch LW_69
LW_69_d:
  s_mov_b64 exec, 1
  ds_add_u32 v125, v126 offset:116
  s_mov_b64 exec, -1
L_P7:
  v_exp_f32 v8, v8
  s_waitcnt lgkmcnt(3)
  v_exp_f32_e64 v9, v9
  v_smfmac_f32_32x32x32_bf16 v[72:87], v[100:103], v[64:71], v7
  ds_read_b128 v[100:103], v6 offset:4128
  v_exp_f32 v10, v10
  v_exp_f32 v11, v11
  v_exp_f32 v12, v12
  v_exp_f32 v13, v13
  v_mfma_f32_32x32x4_2b_bf16 v[40:71], v[112:113], v[114:115], 0
  ds_read_b32 v112, v5 offset:11520
  v_exp_f32 v14, v14
  v_exp_f32 v15, v15
  v_exp_f32 v16, v16
  v_exp_f32 v17, v17
  v_exp_f32 v18, v18
  v_exp_f32 v19, v19
  v_exp_f32 v20, v20
  v_exp_f32 v21, v21
  v_smfmac_f32_32x32x32_bf16 v[72:87], v[88:91], v[8:15], v7
  ds_read_b128 v[88:91], v6 offset:7040
  v_exp_f32 v22, v22
  v_exp_f32 v23, v23
  v_exp_f32 v24, v24
  v_exp_f32 v25, v25
  v_smfmac_f32_32x32x32_bf16 v[72:87], v[92:95], v[16:23], v7
  ds_read_b128 v[92:95], v6 offset:7648
  v_exp_f32 v26, v26
  v_exp_f32 v27, v27
  v_exp_f32 v28, v28
  s_waitcnt lgkmcnt(4)
  v_exp_f32_e64 v29, v29
  v_mfma_f32_32x32x16_bf16 v[40:55], v[104:107], v[116:119], v[40:55]
  ds_read_b128 v[104:107], v4 offset:9472
  v_exp_f32 v30, v30
  v_exp_f32 v31, v31
  v_exp_f32 v32, v32
  v_exp_f32 v33, v33
  v_mfma_f32_32x32x16_bf16 v[56:71], v[108:111], v[116:119], v[56:71]
  ds_read_b128 v[108:111], v4 offset:10496
  v_exp_f32 v34, v34
  v_exp_f32 v35, v35
  v_exp_f32 v36, v36
  v_exp_f32 v37, v37
  v_smfmac_f32_32x32x32_bf16 v[72:87], v[96:99], v[24:31], v7
  ds_read_b128 v[96:99], v6 offset:8256
  v_exp_f32 v38, v38
  v_exp_f32 v39, v39
  s_cmp_lg_u32 s44, 1
  s_cbranch_scc1 L_P2
  s_mov_b64 exec, 1
  ds_add_u32 v125, v126 offset:108
  s_mov_b64 exec, -1
L_P2:
  v_exp_f32 v40, v40
  s_waitcnt lgkmcnt(3)
  v_exp_f32_e64 v41, v41
  v_smfmac_f32_32x32x32_bf16 v[72:87], v[100:103], v[32:39], v7
  ds_read_b128 v[100:103], v6 offset:8864
  v_exp_f32 v42, v42
  v_exp_f32 v43, v43
  v_exp_f32 v44, v44
  v_exp_f32 v45, v45
  v_mfma_f32_32x32x4_2b_bf16 v[8:39], v[112:113], v[114:115], 0
  ds_read_b32 v112, v5 offset:16256
  v_exp_f32 v46, v46
  v_exp_f32 v47, v47
  v_exp_f32 v48, v48
  v_exp_f32 v49, v49
  s_cmp_lt_u32 s18, 4
  s_cbranch_scc1 TG_70
  s_setprio 3
TG_70:
  v_exp_f32 v50, v50
  v_exp_f32 v51, v51
  v_exp_f32 v52, v52
  v_exp_f32 v53, v53
  v_smfmac_f32_32x32x32_bf16 v[72:87], v[88:91], v[40:47], v7
  ds_read_b128 v[88:91], v6 offset:11776
  v_exp_f32 v54, v54
  v_exp_f32 v55, v55
  v_exp_f32 v56, v56
  v_exp_f32 v57, v57
  v_smfmac_f32_32x32x32_bf16 v[72:87], v[92:95], v[48:55], v7
  ds_read_b128 v[92:95], v6 offset:12384
  v_exp_f32 v58, v58
  v_exp_f32 v59, v59
  v_exp_f32 v60, v60
  s_waitcnt lgkmcnt(4)
  v_exp_f32_e64 v61, v61
  v_mfma_f32_32x32x16_bf16 v[8:23], v[104:107], v[116:119], v[8:23]
  ds_read_b128 v[104:107], v4 offset:14208
  v_exp_f32 v62, v62
  v_exp_f32 v63, v63
  v_exp_f32 v64, v64
  v_exp_f32 v65, v65
  v_mfma_f32_32x32x16_bf16 v[24:39], v[108:111], v[116:119], v[24:39]
  ds_read_b128 v[108:111], v4 offset:15232
  v_exp_f32 v66, v66
  v_exp_f32 v67, v67
  v_exp_f32 v68, v68
  v_exp_f32 v69, v69
  v_smfmac_f32_32x32x32_bf16 v[72:87], v[96:99], v[56:63], v7
  ds_read_b128 v[96:99], v6 offset:12992
  v_exp_f32 v70, v70
  v_exp_f32 v71, v71
  v_exp_f32 v8, v8
  s_waitcnt lgkmcnt(3)
  v_exp_f32_e64 v9, v9
  v_smfmac_f32_32x32x32_bf16 v[72:87], v[100:103], v[64:71], v7
  ds_read_b128 v[100:103], v6 offset:13600
  v_exp_f32 v10, v10
  v_exp_f32 v11, v11
  v_exp_f32 v12, v12
  v_exp_f32 v13, v13
  v_mfma_f32_32x32x4_2b_bf16 v[40:71], v[112:113], v[114:115], 0
  ds_read_b32 v112, v5 offset:20992
  v_exp_f32 v14, v14
  v_exp_f32 v15, v15
  v_exp_f32 v16, v16
  v_exp_f32 v17, v17
  v_exp_f32 v18, v18
  v_exp_f32 v19, v19
  v_exp_f32 v20, v20
  v_exp_f32 v21, v21
  v_smfmac_f32_32x32x32_bf16 v[72:87], v[88:91], v[8:15], v7
  ds_read_b128 v[88:91], v6 offset:16512
  v_exp_f32 v22, v22
  v_exp_f32 v23, v23
  v_exp_f32 v24, v24
  v_exp_f32 v25, v25
  v_smfmac_f32_32x32x32_bf16 v[72:87], v[92:95], v[16:23], v7
  ds_read_b128 v[92:95], v6 offset:17120
  v_exp_f32 v26, v26
  v_exp_f32 v27, v27
  v_exp_f32 v28, v28
  s_waitcnt lgkmcnt(4)
  v_exp_f32_e64 v29, v29
  v_mfma_f32_32x32x16_bf16 v[40:55], v[104:107], v[116:119], v[40:55]
  ds_read_b128 v[104:107], v4 offset:18944
  v_exp_f32 v30, v30
  v_exp_f32 v31, v31
  v_exp_f32 v32, v32
  v_exp_f32 v33, v33
  v_mfma_f32_32x32x16_bf16 v[56:71], v[108:111], v[116:119], v[56:71]
  ds_read_b128 v[108:111], v4 offset:19968
  v_exp_f32 v34, v34
  v_exp_f32 v35, v35
  v_exp_f32 v36, v36
  v_exp_f32 v37, v37
  v_smfmac_f32_32x32x32_bf16 v[72:87], v[96:99], v[24:31], v7
  ds_read_b128 v[96:99], v6 offset:17728
  v_exp_f32 v38, v38
  v_exp_f32 v39, v39
  v_exp_f32 v40, v40
  s_waitcnt lgkmcnt(3)
  v_exp_f32_e64 v41, v41
  v_smfmac_f32_32x32x32_bf16 v[72:87], v[100:103], v[32:39], v7
  ds_read_b128 v[100:103], v6 offset:18336
  v_exp_f32 v42, v42
  v_exp_f32 v43, v43
  v_exp_f32 v44, v44
  v_exp_f32 v45, v45
  v_mfma_f32_32x32x4_2b_bf16 v[8:39], v[112:113], v[114:115], 0
  ds_read_b32 v112, v5 offset:25728
  v_exp_f32 v46, v46
  v_exp_f32 v47, v47
  v_exp_f32 v48, v48
  v_exp_f32 v49, v49
  v_exp_f32 v50, v50
  v_exp_f32 v51, v51
  v_exp_f32 v52, v52
  v_exp_f32 v53, v53
  v_smfmac_f32_32x32x32_bf16 v[72:87], v[88:91], v[40:47], v7
  ds_read_b128 v[88:91], v6 offset:21248
  v_exp_f32 v54, v54
  v_exp_f32 v55, v55
  v_exp_f32 v56, v56
  v_exp_f32 v57, v57
  v_smfmac_f32_32x32x32_bf16 v[72:87], v[92:95], v[48:55], v7
  ds_read_b128 v[92:95], v6 offset:21856
  v_exp_f32 v58, v58
  v_exp_f32 v59, v59
  v_exp_f32 v60, v60
  s_waitcnt lgkmcnt(4)
  v_exp_f32_e64 v61, v61
  v_mfma_f32_32x32x16_bf16 v[8:23], v[104:107], v[116:119], v[8:23]
  ds_read_b128 v[104:107], v4 offset:23680
  v_exp_f32 v62, v62
  v_exp_f32 v63, v63
  v_exp_f32 v64, v64
  v_exp_f32 v65, v65
  v_mfma_f32_32x32x16_bf16 v[24:39], v[108:111], v[116:119], v[24:39]
  ds_read_b128 v[108:111], v4 offset:24704
  v_exp_f32 v66, v66
  v_exp_f32 v67, v67
  v_exp_f32 v68, v68
  v_exp_f32 v69, v69
  v_smfmac_f32_32x32x32_bf16 v[72:87], v[96:99], v[56:63], v7
  ds_read_b128 v[96:99], v6 offset:22464
  v_exp_f32 v70, v70
  v_exp_f32 v71, v71
  s_add_u32 s44, s44, 1
  s_cmp_lt_u32 s44, 8
  s_cbranch_scc1 L_LOOP
  s_waitcnt lgkmcnt(0)
  v_smfmac_f32_32x32x32_bf16 v[72:87], v[100:103], v[64:71], v7
L_FIN:
  s_setprio 3
  s_mov_b64 exec, 1
  ds_add_u32 v125, v126 offset:80
  s_mov_b64 exec, -1
  ds_read_b32 v29, v125 offset:52
  v_lshlrev_b32 v4, 4, v2
  s_add_u32 s22, s36, 142848
  s_add_u32 s23, s37, 142848
  v_add_u32 v30, s22, v4
  v_add_u32 v31, s23, v4
  s_nop 1
  v_mov_b32 v8, v82
  v_mov_b32 v9, v82
  s_nop 1
  v_permlane32_swap_b32 v8, v9
  s_nop 1
  v_rcp_f32 v8, v8
  s_nop 0
  v_mul_f32 v72, v8, v72
  v_mul_f32 v73, v8, v73
  v_mul_f32 v74, v8, v74
  v_mul_f32 v75, v8, v75
  v_mul_f32 v76, v8, v76
  v_mul_f32 v77, v8, v77
  v_mul_f32 v78, v8, v78
  v_mul_f32 v79, v8, v79
  v_mul_f32 v80, v8, v80
  v_mul_f32 v81, v8, v81
  v_cvt_pk_bf16_f32 v24, v72, v73
  v_cvt_pk_bf16_f32 v25, v74, v75
  v_cvt_pk_bf16_f32 v26, v76, v77
  v_cvt_pk_bf16_f32 v27, v78, v79
  v_cvt_pk_bf16_f32 v28, v80, v81
  s_cmp_eq_u32 s46, 2
  s_cbranch_scc0 L_OSLOW
  buffer_store_dwordx4 v[24:27], v4, s[24:27], s36 offen
  s_mov_b32 exec_hi, 0
  buffer_store_dword v28, v4, s[24:27], s37 offen
L_OST:
  s_mov_b32 exec_hi, -1
  v_lshrrev_b32 v23, 4, v2
  v_and_b32 v22, 15, v2
  v_and_b32 v16, 12, v2
  v_lshl_add_u32 v16, v3, 4, v16
  v_and_b32 v17, 1, v23
  v_lshl_add_u32 v16, v17, 1, v16
  v_mul_u32_u24 v16, 144, v16
  v_and_b32 v17, 3, v2
  v_lshl_add_u32 v16, v17, 3, v16
  s_lshl_b32 s22, s40, 5
  v_add_u32 v16, s22, v16
  v_add_u32 v17, 41472, v16
  v_lshlrev_b32 v21, 4, v22
  v_lshl_add_u32 v18, v23, 9, v21
  s_lshl_b32 s22, s21, 12
  s_add_u32 s22, s22, 87552
  s_lshl_b32 s23, s21, 9
  s_add_u32 s23, s23, 95744
  v_add_u32 v18, s22, v18
  v_add_u32 v19, 36864, v18
  v_mul_u32_u24 v20, 9216, v23
  v_add3_u32 v20, v20, v21, s23
  v_mul_u32_u24 v22, 2304, v22
  v_lshl_add_u32 v22, v23, 3, v22
  v_and_b32 v21, 7, v2
  v_lshl_add_u32 v21, v21, 2, v125
  v_mov_b32 v8, 0
  v_mov_b32 v9, 0
  v_mov_b32 v10, 0
  v_mov_b32 v11, 0
  v_mov_b32 v12, 0
  v_mov_b32 v13, 0
  v_mov_b32 v14, 0
  v_mov_b32 v15, 0
  v_mul_u32_u24 v22, 2304, v1
  v_lshl_add_u32 v22, v3, 4, v22
  s_mov_b64 exec, 1
  s_waitcnt vmcnt(0) lgkmcnt(0)
  s_cmp_eq_u32 s46, 2
  s_cbranch_scc0 L_FSLOW
  buffer_store_dword v29, v4, s[28:31], 0 offen
L_FST:
  s_mov_b64 exec, -1
LW_71:
  ds_read_b32 v127, v125 offset:76
  s_waitcnt lgkmcnt(0)
  v_readfirstlane_b32 s60, v127
  s_cmp_ge_u32 s60, 1
  s_cbranch_scc1 LW_71_d
  s_sleep 1
  s_branch LW_71
LW_71_d:
  ds_read_b64_tr_b16 v[52:53], v16 offset:0
  ds_read_b64_tr_b16 v[54:55], v16 offset:144
  ds_read_b64_tr_b16 v[56:57], v16 offset:4608
  ds_read_b64_tr_b16 v[58:59], v16 offset:4752
  ds_read_b64_tr_b16 v[60:61], v16 offset:9216
  ds_read_b64_tr_b16 v[62:63], v16 offset:9360
  ds_read_b64_tr_b16 v[64:65], v16 offset:13824
  ds_read_b64_tr_b16 v[66:67], v16 offset:13968
  ds_read_b64_tr_b16 v[68:69], v16 offset:18432
  ds_read_b64_tr_b16 v[70:71], v16 offset:18576
  ds_read_b64_tr_b16 v[72:73], v16 offset:23040
  ds_read_b64_tr_b16 v[74:75], v16 offset:23184
  ds_read_b64_tr_b16 v[76:77], v16 offset:27648
  ds_read_b64_tr_b16 v[78:79], v16 offset:27792
  ds_read_b64_tr_b16 v[80:81], v16 offset:32256
  ds_read_b64_tr_b16 v[82:83], v16 offset:32400
  ds_read_b64_tr_b16 v[84:85], v16 offset:36864
  ds_read_b64_tr_b16 v[86:87], v16 offset:37008
  ds_read_b64_tr_b16 v[88:89], v17 offset:0
  ds_read_b64_tr_b16 v[90:91], v17 offset:144
  ds_read_b64_tr_b16 v[92:93], v17 offset:4608
  ds_read_b64_tr_b16 v[94:95], v17 offset:4752
  ds_read_b64_tr_b16 v[96:97], v17 offset:9216
  ds_read_b64_tr_b16 v[98:99], v17 offset:9360
  ds_read_b64_tr_b16 v[100:101], v17 offset:13824
  ds_read_b64_tr_b16 v[102:103], v17 offset:13968
  ds_read_b64_tr_b16 v[104:105], v17 offset:18432
  ds_read_b64_tr_b16 v[106:107], v17 offset:18576
  ds_read_b64_tr_b16 v[108:109], v17 offset:23040
  ds_read_b64_tr_b16 v[110:111], v17 offset:23184
  ds_read_b64_tr_b16 v[112:113], v17 offset:27648
  ds_read_b64_tr_b16 v[114:115], v17 offset:27792
  ds_read_b64_tr_b16 v[116:117], v17 offset:32256
  ds_read_b64_tr_b16 v[118:119], v17 offset:32400
  ds_read_b64_tr_b16 v[120:121], v17 offset:36864
  ds_read_b64_tr_b16 v[122:123], v17 offset:37008
LW_72:
  ds_read_b32 v127, v125 offset:80
  s_waitcnt lgkmcnt(0)
  v_readfirstlane_b32 s60, v127
  s_cmp_ge_u32 s60, 8
  s_cbranch_scc1 LW_72_d
  s_sleep 1
  s_branch LW_72
LW_72_d:
  ds_write_b128 v30, v[24:27]
  s_mov_b32 exec_hi, 0
  ds_write_b32 v31, v28
  s_mov_b64 exec, 1
  ds_add_u32 v125, v126 offset:152
  s_mov_b64 exec, -1
  s_mov_b32 s48, 0
  s_bitcmp1_b32 s48, 6
  s_cbranch_scc0 L_OS6
L_OR6:
  ds_read_b128 v[24:27], v19 offset:18432
  ds_read_b128 v[28:31], v19 offset:18688
  ds_read_b128 v[32:35], v19 offset:20480
  ds_read_b128 v[36:39], v19 offset:20736
  s_bitcmp1_b32 s48, 0
  s_cbranch_scc0 L_OS0
L_OR0:
  ds_read_b128 v[40:43], v18 offset:0
  ds_read_b128 v[44:47], v18 offset:256
  ds_read_b128 v[48:51], v18 offset:2048
  s_waitcnt lgkmcnt(6)
  v_mfma_f32_16x16x32_bf16 v[8:11], v[100:103], v[24:27], v[8:11]
  ds_read_b128 v[24:27], v18 offset:2304
  s_waitcnt lgkmcnt(6)
  v_mfma_f32_16x16x32_bf16 v[12:15], v[100:103], v[28:31], v[12:15]
  s_bitcmp1_b32 s48, 1
  s_cbranch_scc0 L_OS1
L_OR1:
  ds_read_b128 v[28:31], v18 offset:9216
  s_waitcnt lgkmcnt(6)
  v_mfma_f32_16x16x32_bf16 v[8:11], v[104:107], v[32:35], v[8:11]
  ds_read_b128 v[32:35], v18 offset:9472
  s_waitcnt lgkmcnt(6)
  v_mfma_f32_16x16x32_bf16 v[12:15], v[104:107], v[36:39], v[12:15]
  ds_read_b128 v[36:39], v18 offset:11264
  s_waitcnt lgkmcnt(6)
  v_mfma_f32_16x16x32_bf16 v[8:11], v[52:55], v[40:43], v[8:11]
  ds_read_b128 v[40:43], v18 offset:11520
  s_waitcnt lgkmcnt(6)
  v_mfma_f32_16x16x32_bf16 v[12:15], v[52:55], v[44:47], v[12:15]
  s_bitcmp1_b32 s48, 2
  s_cbranch_scc0 L_OS2
L_OR2:
  ds_read_b128 v[44:47], v18 offset:18432
  s_waitcnt lgkmcnt(6)
  v_mfma_f32_16x16x32_bf16 v[8:11], v[56:59], v[48:51], v[8:11]
  ds_read_b128 v[48:51], v18 offset:18688
  s_waitcnt lgkmcnt(6)
  v_mfma_f32_16x16x32_bf16 v[12:15], v[56:59], v[24:27], v[12:15]
  ds_read_b128 v[24:27], v18 offset:20480
  s_waitcnt lgkmcnt(6)
  v_mfma_f32_16x16x32_bf16 v[8:11], v[60:63], v[28:31], v[8:11]
  ds_read_b128 v[28:31], v18 offset:20736
  s_waitcnt lgkmcnt(6)
  v_mfma_f32_16x16x32_bf16 v[12:15], v[60:63], v[32:35], v[12:15]
  s_bitcmp1_b32 s48, 3
  s_cbranch_scc0 L_OS3
L_OR3:
  ds_read_b128 v[32:35], v18 offset:27648
  s_waitcnt lgkmcnt(6)
  v_mfma_f32_16x16x32_bf16 v[8:11], v[64:67], v[36:39], v[8:11]
  ds_read_b128 v[36:39], v18 offset:27904
  s_waitcnt lgkmcnt(6)
  v_mfma_f32_16x16x32_bf16 v[12:15], v[64:67], v[40:43], v[12:15]
  ds_read_b128 v[40:43], v18 offset:29696
  s_waitcnt lgkmcnt(6)
  v_mfma_f32_16x16x32_bf16 v[8:11], v[68:71], v[44:47], v[8:11]
  ds_read_b128 v[44:47], v18 offset:29952
  s_waitcnt lgkmcnt(6)
  v_mfma_f32_16x16x32_bf16 v[12:15], v[68:71], v[48:51], v[12:15]
  s_bitcmp1_b32 s48, 7
  s_cbranch_scc0 L_OS7
L_OR7:
  ds_read_b128 v[48:51], v19 offset:27648
  s_waitcnt lgkmcnt(6)
  v_mfma_f32_16x16x32_bf16 v[8:11], v[72:75], v[24:27], v[8:11]
  ds_read_b128 v[24:27], v19 offset:27904
  s_waitcnt lgkmcnt(6)
  v_mfma_f32_16x16x32_bf16 v[12:15], v[72:75], v[28:31], v[12:15]
  ds_read_b128 v[28:31], v19 offset:29696
  s_waitcnt lgkmcnt(6)
  v_mfma_f32_16x16x32_bf16 v[8:11], v[76:79], v[32:35], v[8:11]
  ds_read_b128 v[32:35], v19 offset:29952
  s_waitcnt lgkmcnt(6)
  v_mfma_f32_16x16x32_bf16 v[12:15], v[76:79], v[36:39], v[12:15]
  s_bitcmp1_b32 s48, 4
  s_cbranch_scc0 L_OS4
L_OR4:
  ds_read_b128 v[36:39], v19 offset:0
  s_waitcnt lgkmcnt(6)
  v_mfma_f32_16x16x32_bf16 v[8:11], v[80:83], v[40:43], v[8:11]
  ds_read_b128 v[40:43], v19 offset:256
  s_waitcnt lgkmcnt(6)
  v_mfma_f32_16x16x32_bf16 v[12:15], v[80:83], v[44:47], v[12:15]
  ds_read_b128 v[44:47], v19 offset:2048
  s_waitcnt lgkmcnt(6)
  v_mfma_f32_16x16x32_bf16 v[8:11], v[108:111], v[48:51], v[8:11]
  ds_read_b128 v[48:51], v19 offset:2304
  s_waitcnt lgkmcnt(6)
  v_mfma_f32_16x16x32_bf16 v[12:15], v[108:111], v[24:27], v[12:15]
  s_bitcmp1_b32 s48, 5
  s_cbranch_scc0 L_OS5
L_OR5:
  ds_read_b128 v[24:27], v19 offset:9216
  s_waitcnt lgkmcnt(6)
  v_mfma_f32_16x16x32_bf16 v[8:11], v[112:115], v[28:31], v[8:11]
  ds_read_b128 v[28:31], v19 offset:9472
  s_waitcnt lgkmcnt(6)
  v_mfma_f32_16x16x32_bf16 v[12:15], v[112:115], v[32:35], v[12:15]
  ds_read_b128 v[32:35], v19 offset:11264
  s_waitcnt lgkmcnt(6)
  v_mfma_f32_16x16x32_bf16 v[8:11], v[84:87], v[36:39], v[8:11]
  ds_read_b128 v[36:39], v19 offset:11520
  s_waitcnt lgkmcnt(6)
  v_mfma_f32_16x16x32_bf16 v[12:15], v[84:87], v[40:43], v[12:15]
  ds_read_b128 v[40:43], v20 offset:0
  s_waitcnt lgkmcnt(6)
  v_mfma_f32_16x16x32_bf16 v[8:11], v[88:91], v[44:47], v[8:11]
  ds_read_b128 v[44:47], v20 offset:256
  s_waitcnt lgkmcnt(6)
  v_mfma_f32_16x16x32_bf16 v[12:15], v[88:91], v[48:51], v[12:15]
  ds_read_b128 v[48:51], v20 offset:36864
  s_waitcnt lgkmcnt(6)
  v_mfma_f32_16x16x32_bf16 v[8:11], v[92:95], v[24:27], v[8:11]
  ds_read_b128 v[24:27], v20 offset:37120
  s_waitcnt lgkmcnt(6)
  v_mfma_f32_16x16x32_bf16 v[12:15], v[92:95], v[28:31], v[12:15]
  s_waitcnt lgkmcnt(5)
  v_mfma_f32_16x16x32_bf16 v[8:11], v[96:99], v[32:35], v[8:11]
  s_waitcnt lgkmcnt(4)
  v_mfma_f32_16x16x32_bf16 v[12:15], v[96:99], v[36:39], v[12:15]
  s_waitcnt lgkmcnt(3)
  v_mfma_f32_16x16x32_bf16 v[8:11], v[116:119], v[40:43], v[8:11]
  s_waitcnt lgkmcnt(2)
  v_mfma_f32_16x16x32_bf16 v[12:15], v[116:119], v[44:47], v[12:15]
  s_waitcnt lgkmcnt(1)
  v_mfma_f32_16x16x32_bf16 v[8:11], v[120:123], v[48:51], v[8:11]
  s_waitcnt lgkmcnt(0)
  v_mfma_f32_16x16x32_bf16 v[12:15], v[120:123], v[24:27], v[12:15]
  s_mov_b32 s22, 36864
  s_nop 6
  v_cvt_pk_bf16_f32 v24, v8, v9
  v_cvt_pk_bf16_f32 v25, v10, v11
  v_cvt_pk_bf16_f32 v26, v12, v13
  v_cvt_pk_bf16_f32 v27, v14, v15
  s_nop 1
  v_permlane16_swap_b32 v24, v26
  v_permlane16_swap_b32 v25, v27
  buffer_store_dwordx4 v[24:27], v22, s[32:35], 0 offen
  s_endpgm
L_OS6:
  ds_read_b32 v127, v21 offset:128
  s_waitcnt lgkmcnt(0)
  v_cmp_le_u32 vcc, 8, v127
  s_mov_b32 s48, vcc_lo
  s_bitcmp1_b32 s48, 6
  s_cbranch_scc1 L_OR6
  s_sleep 1
  s_branch L_OS6
L_OS0:
  ds_read_b32 v127, v21 offset:128
  s_waitcnt lgkmcnt(0)
  v_cmp_le_u32 vcc, 8, v127
  s_mov_b32 s48, vcc_lo
  s_bitcmp1_b32 s48, 0
  s_cbranch_scc1 L_OR0
  s_sleep 1
  s_branch L_OS0
L_OS1:
  ds_read_b32 v127, v21 offset:128
  s_waitcnt lgkmcnt(0)
  v_cmp_le_u32 vcc, 8, v127
  s_mov_b32 s48, vcc_lo
  s_bitcmp1_b32 s48, 1
  s_cbranch_scc1 L_OR1
  s_sleep 1
  s_branch L_OS1
L_OS2:
  ds_read_b32 v127, v21 offset:128
  s_waitcnt lgkmcnt(0)
  v_cmp_le_u32 vcc, 8, v127
  s_mov_b32 s48, vcc_lo
  s_bitcmp1_b32 s48, 2
  s_cbranch_scc1 L_OR2
  s_sleep 1
  s_branch L_OS2
L_OS3:
  ds_read_b32 v127, v21 offset:128
  s_waitcnt lgkmcnt(0)
  v_cmp_le_u32 vcc, 8, v127
  s_mov_b32 s48, vcc_lo
  s_bitcmp1_b32 s48, 3
  s_cbranch_scc1 L_OR3
  s_sleep 1
  s_branch L_OS3
L_OS7:
  ds_read_b32 v127, v21 offset:128
  s_waitcnt lgkmcnt(0)
  v_cmp_le_u32 vcc, 8, v127
  s_mov_b32 s48, vcc_lo
  s_bitcmp1_b32 s48, 7
  s_cbranch_scc1 L_OR7
  s_sleep 1
  s_branch L_OS7
L_OS4:
  ds_read_b32 v127, v21 offset:128
  s_waitcnt lgkmcnt(0)
  v_cmp_le_u32 vcc, 8, v127
  s_mov_b32 s48, vcc_lo
  s_bitcmp1_b32 s48, 4
  s_cbranch_scc1 L_OR4
  s_sleep 1
  s_branch L_OS4
L_OS5:
  ds_read_b32 v127, v21 offset:128
  s_waitcnt lgkmcnt(0)
  v_cmp_le_u32 vcc, 8, v127
  s_mov_b32 s48, vcc_lo
  s_bitcmp1_b32 s48, 5
  s_cbranch_scc1 L_OR5
  s_sleep 1
  s_branch L_OS5
L_QS1:
  ds_read_b32 v127, v103 offset:0
  s_waitcnt lgkmcnt(0)
  v_cmp_le_u32 vcc, 5, v127
  s_mov_b32 s47, vcc_lo
  s_bitcmp1_b32 s47, 1
  s_cbranch_scc1 L_QR1
  s_sleep 1
  s_branch L_QS1
L_QS2:
  ds_read_b32 v127, v103 offset:0
  s_waitcnt lgkmcnt(0)
  v_cmp_le_u32 vcc, 5, v127
  s_mov_b32 s47, vcc_lo
  s_bitcmp1_b32 s47, 2
  s_cbranch_scc1 L_QR2
  s_sleep 1
  s_branch L_QS2
L_QS3:
  ds_read_b32 v127, v103 offset:0
  s_waitcnt lgkmcnt(0)
  v_cmp_le_u32 vcc, 5, v127
  s_mov_b32 s47, vcc_lo
  s_bitcmp1_b32 s47, 3
  s_cbranch_scc1 L_QR3
  s_sleep 1
  s_branch L_QS3
L_QS4:
  ds_read_b32 v127, v103 offset:0
  s_waitcnt lgkmcnt(0)
  v_cmp_le_u32 vcc, 5, v127
  s_mov_b32 s47, vcc_lo
  s_bitcmp1_b32 s47, 4
  s_cbranch_scc1 L_QR4
  s_sleep 1
  s_branch L_QS4
L_QS5:
  ds_read_b32 v127, v103 offset:0
  s_waitcnt lgkmcnt(0)
  v_cmp_le_u32 vcc, 5, v127
  s_mov_b32 s47, vcc_lo
  s_bitcmp1_b32 s47, 5
  s_cbranch_scc1 L_QR5
  s_sleep 1
  s_branch L_QS5
L_QS6:
  ds_read_b32 v127, v103 offset:0
  s_waitcnt lgkmcnt(0)
  v_cmp_le_u32 vcc, 5, v127
  s_mov_b32 s47, vcc_lo
  s_bitcmp1_b32 s47, 6
  s_cbranch_scc1 L_QR6
  s_sleep 1
  s_branch L_QS6
L_QS7:
  ds_read_b32 v127, v103 offset:0
  s_waitcnt lgkmcnt(0)
  v_cmp_le_u32 vcc, 5, v127
  s_mov_b32 s47, vcc_lo
  s_bitcmp1_b32 s47, 7
  s_cbranch_scc1 L_QR7
  s_sleep 1
  s_branch L_QS7
L_QS8:
  ds_read_b32 v127, v103 offset:0
  s_waitcnt lgkmcnt(0)
  v_cmp_le_u32 vcc, 5, v127
  s_mov_b32 s47, vcc_lo
  s_bitcmp1_b32 s47, 8
  s_cbranch_scc1 L_QR8
  s_sleep 1
  s_branch L_QS8
L_OSLOW:
  buffer_store_dwordx4 v[24:27], v4, s[24:27], s36 offen sc1
  s_mov_b32 exec_hi, 0
  buffer_store_dword v28, v4, s[24:27], s37 offen sc1
  s_branch L_OST
L_FSLOW:
  buffer_store_dword v29, v4, s[28:31], 0 offen sc1
  s_branch L_FST
L_SLOW:
LW_73:
  ds_read_b32 v127, v125 offset:56
  s_waitcnt lgkmcnt(0)
  v_readfirstlane_b32 s43, v127
  s_cmp_ge_u32 s43, 32
  s_cbranch_scc1 LW_73_d
  s_sleep 1
  s_branch LW_73
LW_73_d:
  v_mov_b32 v115, 0
  v_mov_b32 v123, 0xff800000
  v_mov_b32 v120, v4
  v_mov_b32 v121, v5
  s_nop 11
  s_mov_b32 s44, 0
L_SLOW1:
  ds_read_b32 v112, v121 offset:2048
  ds_read_b128 v[104:107], v120
  ds_read_b128 v[108:111], v120 offset:1024
  s_waitcnt lgkmcnt(0)
  v_mfma_f32_32x32x16_bf16 v[8:23], v[104:107], v[116:119], 0
  v_mfma_f32_32x32x16_bf16 v[24:39], v[108:111], v[116:119], 0
  s_nop 9
  v_mfma_f32_32x32x4_2b_bf16 v[8:39], v[112:113], v[114:115], v[8:39]
  v_add_u32 v120, 4736, v120
  v_add_u32 v121, 4736, v121
  s_nop 15
  s_nop 3
  v_max3_f32 v123, v123, v8, v9
  v_max3_f32 v123, v123, v10, v11
  v_max3_f32 v123, v123, v12, v13
  v_max3_f32 v123, v123, v14, v15
  v_max3_f32 v123, v123, v16, v17
  v_max3_f32 v123, v123, v18, v19
  v_max3_f32 v123, v123, v20, v21
  v_max3_f32 v123, v123, v22, v23
  v_max3_f32 v123, v123, v24, v25
  v_max3_f32 v123, v123, v26, v27
  v_max3_f32 v123, v123, v28, v29
  v_max3_f32 v123, v123, v30, v31
  v_max3_f32 v123, v123, v32, v33
  v_max3_f32 v123, v123, v34, v35
  v_max3_f32 v123, v123, v36, v37
  v_max3_f32 v123, v123, v38, v39
  s_add_u32 s44, s44, 1
  s_cmp_lt_u32 s44, 32
  s_cbranch_scc1 L_SLOW1
  v_mov_b32 v124, v123
  s_nop 1
  v_permlane32_swap_b32 v123, v124
  s_nop 1
  v_max_f32 v123, v123, v124
  v_mov_b32 v120, v4
  v_mov_b32 v121, v5
  s_mov_b32 s44, 0
L_SLOW2:
  ds_read_b128 v[88:91], v6 offset:2304
  ds_read_b128 v[92:95], v6 offset:2912
  ds_read_b128 v[96:99], v6 offset:3520
  ds_read_b128 v[100:103], v6 offset:4128
  ds_read_b32 v112, v121 offset:2048
  ds_read_b128 v[104:107], v120
  ds_read_b128 v[108:111], v120 offset:1024
  s_waitcnt lgkmcnt(0)
  v_mfma_f32_32x32x16_bf16 v[8:23], v[104:107], v[116:119], 0
  v_mfma_f32_32x32x16_bf16 v[24:39], v[108:111], v[116:119], 0
  s_nop 9
  v_mfma_f32_32x32x4_2b_bf16 v[8:39], v[112:113], v[114:115], v[8:39]
  v_add_u32 v120, 4736, v120
  v_add_u32 v121, 4736, v121
  s_nop 15
  s_nop 3
  v_add_u32 v6, 4736, v6
  v_sub_f32 v8, v8, v123
  v_sub_f32 v9, v9, v123
  v_sub_f32 v10, v10, v123
  v_sub_f32 v11, v11, v123
  v_sub_f32 v12, v12, v123
  v_sub_f32 v13, v13, v123
  v_sub_f32 v14, v14, v123
  v_sub_f32 v15, v15, v123
  v_sub_f32 v16, v16, v123
  v_sub_f32 v17, v17, v123
  v_sub_f32 v18, v18, v123
  v_sub_f32 v19, v19, v123
  v_sub_f32 v20, v20, v123
  v_sub_f32 v21, v21, v123
  v_sub_f32 v22, v22, v123
  v_sub_f32 v23, v23, v123
  v_sub_f32 v24, v24, v123
  v_sub_f32 v25, v25, v123
  v_sub_f32 v26, v26, v123
  v_sub_f32 v27, v27, v123
  v_sub_f32 v28, v28, v123
  v_sub_f32 v29, v29, v123
  v_sub_f32 v30, v30, v123
  v_sub_f32 v31, v31, v123
  v_sub_f32 v32, v32, v123
  v_sub_f32 v33, v33, v123
  v_sub_f32 v34, v34, v123
  v_sub_f32 v35, v35, v123
  v_sub_f32 v36, v36, v123
  v_sub_f32 v37, v37, v123
  v_sub_f32 v38, v38, v123
  v_sub_f32 v39, v39, v123
  v_exp_f32 v8, v8
  v_exp_f32 v9, v9
  v_exp_f32 v10, v10
  v_exp_f32 v11, v11
  v_exp_f32 v12, v12
  v_exp_f32 v13, v13
  v_exp_f32 v14, v14
  v_exp_f32 v15, v15
  v_exp_f32 v16, v16
  v_exp_f32 v17, v17
  v_exp_f32 v18, v18
  v_exp_f32 v19, v19
  v_exp_f32 v20, v20
  v_exp_f32 v21, v21
  v_exp_f32 v22, v22
  v_exp_f32 v23, v23
  v_exp_f32 v24, v24
  v_exp_f32 v25, v25
  v_exp_f32 v26, v26
  v_exp_f32 v27, v27
  v_exp_f32 v28, v28
  v_exp_f32 v29, v29
  v_exp_f32 v30, v30
  v_exp_f32 v31, v31
  v_exp_f32 v32, v32
  v_exp_f32 v33, v33
  v_exp_f32 v34, v34
  v_exp_f32 v35, v35
  v_exp_f32 v36, v36
  v_exp_f32 v37, v37
  v_exp_f32 v38, v38
  v_exp_f32 v39, v39
  s_nop 1
  v_smfmac_f32_32x32x32_bf16 v[72:87], v[88:91], v[8:15], v7
  v_smfmac_f32_32x32x32_bf16 v[72:87], v[92:95], v[16:23], v7
  v_smfmac_f32_32x32x32_bf16 v[72:87], v[96:99], v[24:31], v7
  v_smfmac_f32_32x32x32_bf16 v[72:87], v[100:103], v[32:39], v7
  s_nop 7
  s_add_u32 s44, s44, 1
  s_cmp_lt_u32 s44, 32
  s_cbranch_scc1 L_SLOW2
  s_mov_b64 exec, 1
  ds_add_u32 v125, v126 offset:108
  s_mov_b64 exec, -1
  s_mov_b64 exec, 1
  ds_add_u32 v125, v126 offset:68
  s_mov_b64 exec, -1
  s_mov_b64 exec, 1
  ds_add_u32 v125, v126 offset:72
  s_mov_b64 exec, -1
  s_mov_b64 exec, 1
  ds_add_u32 v125, v126 offset:116
  s_mov_b64 exec, -1
LW_74:
  ds_read_b32 v127, v125 offset:112
  s_waitcnt lgkmcnt(0)
  v_readfirstlane_b32 s46, v127
  s_cmp_ge_u32 s46, 1
  s_cbranch_scc1 LW_74_d
  s_sleep 4
  s_branch LW_74
LW_74_d:
  s_branch L_FIN
L_END:
  s_endpgm
L_CODE_END:
.section .rodata,"a"
.p2align 6
.amdhsa_kernel concat_heads__ssm_conv_h3__grouped_kv_mqa__prompt_kernel
  .amdhsa_next_free_vgpr 128
  .amdhsa_next_free_sgpr 100
  .amdhsa_accum_offset 128
  .amdhsa_group_segment_fixed_size 0
  .amdhsa_kernarg_size 112
  .amdhsa_user_sgpr_count 2
  .amdhsa_user_sgpr_kernarg_segment_ptr 1
  .amdhsa_system_sgpr_workgroup_id_x 1
  .amdhsa_float_denorm_mode_32 3
.end_amdhsa_kernel
```
